```python
import torch

def _softmax(x, axis=-1):
    return torch.softmax(x, dim=axis)
def _gelu(x):
    return torch.nn.functional.gelu(x, approximate="tanh")
def _silu(x):
    return torch.nn.functional.silu(x)
def _sigmoid(x):
    return torch.sigmoid(x)
def _layernorm(x, axis=-1, eps=1e-5):
    m = x.mean(dim=axis, keepdim=True)
    v = x.var(dim=axis, keepdim=True, unbiased=False)
    return (x - m) / torch.sqrt(v + eps)
def _scatter_add(tgt, idx, src, axis=0):
    return tgt.clone().index_add_(axis, idx, src)
def _segment_sum(src, seg, n):
    out = torch.zeros((n,) + src.shape[1:], dtype=src.dtype)
    return out.index_add_(0, seg, src)
def _pad(x, pw):
    flat = tuple(v for pair in reversed(pw) for v in pair)
    return torch.nn.functional.pad(x, flat)

kernel_name = 'gather_scatter__cheap_equivariant_egnn__graph'

def setup_inputs():

    _w = (lambda a: (lambda t: t.to(torch.bfloat16) if t.is_floating_point() else t)(torch.as_tensor(a)))
    N, deg, D, De = 12500, 64, 64, max(0, 1)
    E = N * deg
    return {
        "h": _w((lambda *s: torch.randn(*s, dtype=torch.bfloat16) * 0.1)(N, D)),
        "pos": _w((lambda *s: torch.randn(*s, dtype=torch.bfloat16) * 0.8)(N, 3)),
        "e_attr": _w((lambda *s: torch.randn(*s, dtype=torch.bfloat16) * 0.8)(E, De)),
        "src": _w((lambda lo, hi, *s: torch.randint(lo, hi, s))(0, N, E).to(torch.int64)),
        "dst": _w((lambda lo, hi, *s: torch.randint(lo, hi, s))(0, N, E).to(torch.int64)),
        "w_e": _w(0.1 * (lambda *s: torch.randn(*s, dtype=torch.bfloat16) * 0.8)(2 * D + 1 + De, D)),
        "w_x": _w(0.1 * (lambda *s: torch.randn(*s, dtype=torch.bfloat16) * 0.1)(D, 1)),
        "w_h": _w(0.1 * (lambda *s: torch.randn(*s, dtype=torch.bfloat16) * 0.1)(2 * D, D)),
    }

def reference(h, pos, e_attr, src, dst, w_e, w_x, w_h):
    N, D = h.shape[0], h.shape[1]
    diff = pos[dst] - pos[src]
    dist2 = torch.sum(diff * diff, axis=-1, keepdims=True)
    e_in = torch.concatenate([h[dst], h[src], dist2, e_attr], axis=-1)
    m_ij = _silu(e_in @ w_e)
    coord_scale = m_ij @ w_x
    pos_new = pos + _segment_sum(diff * coord_scale, dst, N)
    m_i = _segment_sum(m_ij, dst, N)
    h_new = h + _silu(torch.concatenate([h, m_i], axis=-1) @ w_h)
    return h_new, pos_new
```

```asm
; @launch grid=(256,1,1) block=(512,1,1) lds=163840
.amdgcn_target "amdgcn-amd-amdhsa--gfx950"
.text
    .globl gather_scatter__cheap_equivariant_egnn__graph_kernel
    .p2align 8
    .type gather_scatter__cheap_equivariant_egnn__graph_kernel,@function
gather_scatter__cheap_equivariant_egnn__graph_kernel:
    s_cmp_ge_u32 s2, 256
    s_cbranch_scc1 L_END
    s_load_dwordx16 s[4:19], s[0:1], 0
    s_load_dwordx2 s[20:21], s[0:1], 64
    s_load_dwordx4 s[24:27], s[0:1], 72
    s_memrealtime s[68:69]
    v_lshrrev_b32 v158, 6, v0
    v_and_b32 v1, 63, v0
    v_readfirstlane_b32 s61, v158
    s_cmp_eq_u32 s61, 7
    s_cbranch_scc0 L_NOIPF
    s_getpc_b64 s[48:49]
    s_lshr_b32 s3, s2, 3
    s_and_b32 s3, s3, 31
    s_mul_i32 s3, s3, (CODE_LAST - gather_scatter__cheap_equivariant_egnn__graph_kernel) / 32
    v_lshl_add_u32 v223, v1, 6, s3
    v_min_u32 v223, CODE_LAST - gather_scatter__cheap_equivariant_egnn__graph_kernel - 128, v223
    s_mov_b64 exec, 0xffff
    global_load_dword v224, v223, s[48:49]
    s_mov_b64 exec, -1
L_NOIPF:
    v_mov_b32 v10, 0
    v_mov_b32 v11, 0
    v_mov_b32 v12, 0
    v_mov_b32 v13, 0
    v_lshlrev_b32 v158, 3, v0
    v_and_b32 v161, 31, v1
    v_and_b32 v159, 0x3f8, v158
    ds_write_b64 v158, v[10:11] offset:14336
    ds_write_b64 v159, v[10:11] offset:0
    v_lshrrev_b32 v160, 5, v1
    v_lshlrev_b32 v237, 2, v1
    s_and_b32 s60, s2, 7
    s_lshl_b32 s60, s60, 5
    s_lshr_b32 s3, s2, 3
    s_add_u32 s60, s60, s3
    s_mul_i32 s101, s60, 49
    s_mul_i32 s96, s2, 12512
    s_lshr_b32 s97, s96, 1
    v_lshlrev_b32 v150, 5, v0
    v_lshlrev_b32 v151, 4, v0
    v_lshlrev_b32 v152, 4, v1
    s_mov_b32 s66, 3200000
    s_mov_b32 s67, 0x20000
    v_lshrrev_b32 v159, 3, v1
    v_and_b32 v158, 7, v1
    v_xor_b32 v158, v158, v159
    v_lshlrev_b32 v158, 4, v158
    v_lshl_add_u32 v153, v159, 7, v158
    s_lshl_b32 s98, s61, 10
    s_lshl_b32 s99, s101, 7
    s_add_u32 s99, s99, s98
    s_mov_b32 s78, 1600000
    s_mov_b32 s79, 0x20000
    s_mov_b32 s82, 16640
    s_mov_b32 s83, 0x20000
    s_add_u32 m0, s98, 103936
    s_add_u32 s3, s98, 8192
    s_or_b32 s100, s2, s61
    s_waitcnt lgkmcnt(0)
    s_cbranch_scc1 L_NONONCE
    s_or_b32 s69, s69, 0x80000000
    v_mov_b32 v172, s68
    v_mov_b32 v173, s69
    s_mov_b64 exec, 1
    global_store_dwordx2 v10, v[172:173], s[24:25] sc1
    s_mov_b64 exec, -1
L_NONONCE:
    s_mov_b64 s[76:77], s[4:5]
    s_mov_b64 s[80:81], s[14:15]
    s_cmp_eq_u32 s61, 6
    s_cbranch_scc1 L_W6LD
L_W6E:
    buffer_load_dwordx4 v153, s[76:79], s99 offen lds
    s_add_u32 m0, s98, 2048
    s_mov_b64 s[64:65], s[12:13]
    buffer_load_dwordx4 v152, s[80:83], s3 offen lds
    s_mov_b32 s36, s26
    s_mov_b32 s37, s27
    s_mov_b32 s38, 9441280
    s_mov_b32 s39, 0x20000
    s_mov_b32 s40, s20
    s_mov_b32 s41, s21
    s_mov_b32 s42, 1675000
    s_mov_b32 s43, 0x20000
    v_lshlrev_b32 v245, 2, v161
    v_add_u32 v245, 15360, v245
    v_bfe_u32 v158, v1, 2, 2
    v_bfe_u32 v174, v1, 4, 1
    v_and_b32 v175, 3, v1
    v_lshlrev_b32 v175, 3, v175
    v_lshl_add_u32 v174, v174, 5, v175
    v_lshl_add_u32 v175, v160, 2, v158
    v_lshl_add_u32 v229, v175, 6, v174
    v_lshl_add_u32 v175, v160, 3, v158
    v_lshl_add_u32 v162, v175, 7, v174
    s_mov_b32 s68, s10
    s_mov_b32 s69, s11
    s_mov_b32 s70, 3200000
    s_mov_b32 s71, 0x20000
    s_mov_b32 s72, s8
    s_mov_b32 s73, s9
    s_mov_b32 s74, 1600000
    s_mov_b32 s75, 0x20000
    s_mov_b32 s92, s18
    s_mov_b32 s93, s19
    s_mov_b32 s94, 16384
    s_mov_b32 s95, 0x20000
    s_movk_i32 s3, 295
    s_cmp_eq_u32 s2, 255
    s_cselect_b32 s3, s3, 391
    v_cmp_gt_u32 s[84:85], s3, v0
    s_mov_b32 s86, 599187
    s_mov_b32 s87, 85599
    s_mov_b32 s88, 200
    s_mov_b32 s89, -3584
    s_mov_b32 s90, 0xffff0000
    v_and_b32 v158, 7, v1
    v_xor_b32 v159, v158, v160
    v_lshlrev_b32 v159, 4, v159
    v_lshl_add_u32 v154, v158, 7, v159
    s_add_u32 s3, s98, 103936
    v_add_u32 v154, s3, v154
    v_xor_b32 v155, 32, v154
    v_xor_b32 v156, 64, v154
    v_xor_b32 v157, 96, v154
    s_mov_b32 s76, 0xbfb8aa3b
    s_mov_b32 s77, 0xbfb8aa3b
    v_mov_b32 v174, 0xda24260
    v_mov_b32 v175, 0xda24260
    s_add_u32 s3, s98, 71936
    v_lshlrev_b32 v164, 9, v160
    v_lshl_add_u32 v164, v161, 2, v164
    v_add_u32 v164, s3, v164
    v_add_u32 v165, s3, v152
    v_mov_b32 v159, 1
    s_cmp_eq_u32 s61, 7
    s_cbranch_scc1 L_TLBD
    buffer_load_dwordx4 v[14:17], v150, s[64:67], s96 offen
    buffer_load_dwordx4 v[18:21], v150, s[64:67], s96 offen offset:16
L_TLBD:
    v_pk_mov_b32 v[30:31], v[10:11], v[10:11]
    v_pk_mov_b32 v[32:33], v[10:11], v[10:11]
    s_cmp_eq_u32 s61, 7
    s_cbranch_scc1 L_W7A
    s_waitcnt vmcnt(2)
    s_barrier
    buffer_load_dwordx4 v[30:33], v151, s[72:75], s97 offen
    buffer_load_dwordx4 v[22:25], v150, s[68:71], s96 offen
    buffer_load_dwordx4 v[26:29], v150, s[68:71], s96 offen offset:16
    ds_read_b128 v[134:137], v154
    ds_read_b128 v[138:141], v155
    ds_read_b128 v[142:145], v156
    ds_read_b128 v[146:149], v157
    ds_read_b64_tr_b16 v[102:103], v162 offset:2048
    ds_read_b64_tr_b16 v[104:105], v162 offset:2560
    ds_read_b64_tr_b16 v[106:107], v162 offset:4096
    ds_read_b64_tr_b16 v[108:109], v162 offset:4608
    ds_read_b64_tr_b16 v[110:111], v162 offset:6144
    ds_read_b64_tr_b16 v[112:113], v162 offset:6656
    ds_read_b64_tr_b16 v[114:115], v162 offset:8192
    ds_read_b64_tr_b16 v[116:117], v162 offset:8704
    ds_read_b64_tr_b16 v[118:119], v162 offset:2112
    ds_read_b64_tr_b16 v[120:121], v162 offset:2624
    ds_read_b64_tr_b16 v[122:123], v162 offset:4160
    s_waitcnt lgkmcnt(11)
    ds_read_b64_tr_b16 v[124:125], v162 offset:4672
    ds_read_b64_tr_b16 v[126:127], v162 offset:6208
    ds_read_b64_tr_b16 v[128:129], v162 offset:6720
    ds_read_b64_tr_b16 v[130:131], v162 offset:8256
    ds_read_b64_tr_b16 v[132:133], v162 offset:8768
    s_waitcnt vmcnt(4) lgkmcnt(8)
    v_mfma_f32_32x32x16_bf16 v[184:199], v[134:137], v[102:105], 0
    v_lshlrev_b32 v158, 10, v14
    v_mul_hi_u32_u24 v46, s87, v158
    v_mul_hi_u32_u24 v78, s86, v158
    v_lshlrev_b32 v46, 2, v46
    v_mfma_f32_32x32x16_bf16 v[184:199], v[138:141], v[106:109], v[184:199]
    v_lshlrev_b32 v158, 10, v15
    v_mul_hi_u32_u24 v47, s87, v158
    v_mul_hi_u32_u24 v79, s86, v158
    v_lshlrev_b32 v47, 2, v47
    v_mfma_f32_32x32x16_bf16 v[184:199], v[142:145], v[110:113], v[184:199]
    v_lshlrev_b32 v158, 10, v16
    v_mul_hi_u32_u24 v48, s87, v158
    v_mul_hi_u32_u24 v80, s86, v158
    v_lshlrev_b32 v48, 2, v48
    v_mfma_f32_32x32x16_bf16 v[184:199], v[146:149], v[114:117], v[184:199]
    v_lshlrev_b32 v158, 10, v17
    v_mul_hi_u32_u24 v49, s87, v158
    v_mul_hi_u32_u24 v81, s86, v158
    v_lshlrev_b32 v49, 2, v49
    s_waitcnt vmcnt(3) lgkmcnt(0)
    v_mfma_f32_32x32x16_bf16 v[200:215], v[134:137], v[118:121], 0
    v_lshlrev_b32 v158, 10, v18
    v_mul_hi_u32_u24 v50, s87, v158
    v_mul_hi_u32_u24 v82, s86, v158
    v_lshlrev_b32 v50, 2, v50
    v_mfma_f32_32x32x16_bf16 v[200:215], v[138:141], v[122:125], v[200:215]
    v_lshlrev_b32 v158, 10, v19
    v_mul_hi_u32_u24 v51, s87, v158
    v_mul_hi_u32_u24 v83, s86, v158
    v_lshlrev_b32 v51, 2, v51
    v_mfma_f32_32x32x16_bf16 v[200:215], v[142:145], v[126:129], v[200:215]
    v_lshlrev_b32 v158, 10, v20
    v_mul_hi_u32_u24 v52, s87, v158
    v_mul_hi_u32_u24 v84, s86, v158
    v_lshlrev_b32 v52, 2, v52
    v_mfma_f32_32x32x16_bf16 v[200:215], v[146:149], v[130:133], v[200:215]
    v_lshlrev_b32 v158, 10, v21
    v_mul_hi_u32_u24 v53, s87, v158
    v_mul_hi_u32_u24 v85, s86, v158
    v_lshlrev_b32 v53, 2, v53
    s_mov_b64 exec, s[84:85]
    ds_add_rtn_u32 v70, v46, v159 offset:0
    ds_add_rtn_u32 v71, v47, v159 offset:0
    ds_add_rtn_u32 v72, v48, v159 offset:0
    ds_add_rtn_u32 v73, v49, v159 offset:0
    ds_add_rtn_u32 v74, v50, v159 offset:0
    ds_add_rtn_u32 v75, v51, v159 offset:0
    ds_add_rtn_u32 v76, v52, v159 offset:0
    ds_add_rtn_u32 v77, v53, v159 offset:0
    s_mov_b64 exec, -1
    v_pk_mul_f32 v[184:185], v[184:185], s[76:77]
    v_pk_mul_f32 v[186:187], v[186:187], s[76:77]
    v_max3_f32 v192, |v184|, |v185|, |v186|
    v_max_f32 v192, v192, |v187|
    v_cvt_pk_bf16_f32 v184, v184, 0
    v_cvt_pk_bf16_f32 v185, v185, 0
    v_cvt_pk_bf16_f32 v186, v186, 0
    v_cvt_pk_bf16_f32 v187, v187, 0
    v_pk_fma_f32 v[200:201], v[200:201], s[76:77], v[174:175]
    v_pk_fma_f32 v[202:203], v[202:203], s[76:77], v[174:175]
    v_max3_f32 v192, v192, |v200|, |v201|
    v_max3_f32 v192, v192, |v202|, |v203|
    v_sub_u32 v200, v200, v184
    v_sub_u32 v201, v201, v185
    v_sub_u32 v202, v202, v186
    v_sub_u32 v203, v203, v187
    v_add_u32 v200, 0x8000, v200
    v_add_u32 v201, 0x8000, v201
    v_add_u32 v202, 0x8000, v202
    v_add_u32 v203, 0x8000, v203
    v_and_or_b32 v200, v200, s90, v184
    v_and_or_b32 v201, v201, s90, v185
    v_and_or_b32 v202, v202, s90, v186
    v_and_or_b32 v203, v203, s90, v187
    ds_write_b32 v164, v200 offset:0
    ds_write_b32 v164, v201 offset:128
    ds_write_b32 v164, v202 offset:256
    ds_write_b32 v164, v203 offset:384
    ds_read_b128 v[188:191], v165
    ds_max_u32 v245, v192 offset:2048
    global_load_dwordx2 v[172:173], v10, s[24:25] sc1
    s_add_u32 m0, s98, 95744
    s_add_u32 s21, s98, 8192
    buffer_load_dwordx4 v152, s[80:83], s98 offen lds
    s_add_u32 m0, s98, 79360
    s_nop 0
    buffer_load_dwordx4 v152, s[92:95], s98 offen lds
    s_add_u32 m0, s98, 87552
    s_nop 0
    buffer_load_dwordx4 v152, s[92:95], s21 offen lds
    s_cmp_eq_u32 s61, 6
    s_cselect_b64 s[64:65], 0xff, -1
    s_waitcnt lgkmcnt(6)
    s_barrier
    ds_read_b128 v[86:89], v152 offset:0
    s_mov_b64 exec, s[64:65]
    s_waitcnt lgkmcnt(2)
    buffer_store_dwordx4 v[188:191], v152, s[36:39], s99 offen sc1
    s_mov_b64 exec, -1
L_W6D:
    v_add_u32 v166, 44800, v151
    v_mov_b32 v167, 0xffff
    s_waitcnt lgkmcnt(0)
    v_add_u32 v98, 1, v86
    v_add_u32 v99, 1, v87
    v_add_u32 v100, 1, v88
    v_add_u32 v101, 1, v89
    v_and_b32 v98, -2, v98
    v_and_b32 v99, -2, v99
    v_and_b32 v100, -2, v100
    v_and_b32 v101, -2, v101
    v_add_u32 v90, v98, v99
    v_add_u32 v91, v90, v100
    v_add_u32 v92, v91, v101
    v_mov_b32 v94, v92
    v_mul_u32_u24 v54, 264, v14
    v_mad_u32_u24 v54, v78, s88, v54
    v_mad_i32_i24 v54, v46, s89, v54
    v_add_u32_dpp v94, v94, v94 row_shr:1 row_mask:0xf bank_mask:0xf bound_ctrl:0
    v_mul_u32_u24 v55, 264, v15
    v_mad_u32_u24 v55, v79, s88, v55
    v_mad_i32_i24 v55, v47, s89, v55
    v_add_u32_dpp v94, v94, v94 row_shr:2 row_mask:0xf bank_mask:0xf bound_ctrl:0
    v_mul_u32_u24 v56, 264, v16
    v_mad_u32_u24 v56, v80, s88, v56
    v_mad_i32_i24 v56, v48, s89, v56
    v_add_u32_dpp v94, v94, v94 row_shr:4 row_mask:0xf bank_mask:0xf bound_ctrl:0
    v_mul_u32_u24 v57, 264, v17
    v_mad_u32_u24 v57, v81, s88, v57
    v_mad_i32_i24 v57, v49, s89, v57
    v_add_u32_dpp v94, v94, v94 row_shr:8 row_mask:0xf bank_mask:0xf bound_ctrl:0
    v_mul_u32_u24 v58, 264, v18
    v_mad_u32_u24 v58, v82, s88, v58
    v_mad_i32_i24 v58, v50, s89, v58
    v_add_u32_dpp v94, v94, v94 row_bcast:15 row_mask:0xa bank_mask:0xf
    v_mul_u32_u24 v59, 264, v19
    v_mad_u32_u24 v59, v83, s88, v59
    v_mad_i32_i24 v59, v51, s89, v59
    v_add_u32_dpp v94, v94, v94 row_bcast:31 row_mask:0xc bank_mask:0xf
    v_mul_u32_u24 v60, 264, v20
    v_mad_u32_u24 v60, v84, s88, v60
    v_mad_i32_i24 v60, v52, s89, v60
    v_readlane_b32 s100, v94, 63
    v_sub_u32 v94, v94, v92
    v_add_u32 v95, v94, v98
    v_add_u32 v96, v94, v90
    v_add_u32 v97, v94, v91
    ds_write_b128 v152, v[94:97] offset:1024
    v_mul_u32_u24 v61, 264, v21
    v_mad_u32_u24 v61, v85, s88, v61
    v_mad_i32_i24 v61, v53, s89, v61
    s_mov_b64 exec, s[84:85]
    ds_read_b32 v78, v46 offset:1024
    ds_read_b32 v79, v47 offset:1024
    ds_read_b32 v80, v48 offset:1024
    ds_read_b32 v81, v49 offset:1024
    ds_read_b32 v82, v50 offset:1024
    ds_read_b32 v83, v51 offset:1024
    ds_read_b32 v84, v52 offset:1024
    ds_read_b32 v85, v53 offset:1024
    s_mov_b64 exec, -1
    s_mul_i32 s68, s2, 27264
    s_add_u32 s68, s68, 2457600
    s_add_u32 s69, s68, 8192
    s_add_u32 s70, s68, 16384
    s_add_u32 s71, s68, 24576
    s_lshr_b32 s100, s100, 1
    s_sub_u32 s100, s100, 1536
    v_cmp_gt_i32 vcc, s100, v0
    s_mov_b32 s28, s26
    s_or_b32 s29, s27, 0x80000000
    s_mov_b32 s30, 9441280
    s_mov_b32 s31, 0x00C00000
    s_add_u32 s32, s26, 1638400
    s_addc_u32 s33, s27, 0
    s_or_b32 s33, s33, 0x40000
    s_mov_b32 s34, 50176
    s_mov_b32 s35, 0x20000
    s_mul_i32 s3, s61, 6144
    s_add_u32 s3, s3, 114688
    v_lshrrev_b32 v174, 3, v1
    v_and_b32 v158, 7, v1
    v_lshlrev_b32 v244, 1, v158
    v_mul_u32_u24 v243, 27264, v174
    v_lshl_add_u32 v243, v158, 4, v243
    v_mov_b32 v222, 0x3f80
    v_lshl_add_u32 v230, v1, 6, s3
    v_lshlrev_b32 v236, 4, v160
    v_add_u32 v229, s3, v229
    s_add_u32 s3, s3, 4096
    v_lshl_add_u32 v231, v1, 4, s3
    v_add_u32 v225, 1024, v231
    v_lshlrev_b32 v158, 10, v160
    v_lshl_add_u32 v158, v161, 4, v158
    v_add_u32 v228, s3, v158
    v_lshrrev_b32 v235, 2, v161
    v_lshl_add_u32 v235, v235, 8, v236
    v_mul_u32_u24 v158, 7168, v160
    v_lshl_add_u32 v158, v161, 4, v158
    v_add_u32 v233, 18688, v158
    v_sub_u32 v234, 1, v160
    v_lshlrev_b32 v234, 10, v234
    s_lshl_b32 s14, s61, 16
    s_lshr_b32 s3, s60, 1
    s_lshl_b32 s3, s3, 4
    s_add_u32 s14, s14, s3
    s_add_u32 s14, s14, 1900544
    s_add_u32 s15, s14, 16384
    s_add_u32 s16, s14, 32768
    s_add_u32 s17, s14, 49152
    v_lshrrev_b32 v223, 3, v1
    v_lshlrev_b32 v223, 11, v223
    s_cmp_eq_u32 s61, 7
    s_cbranch_scc1 L_W7W
    s_mov_b64 exec, s[84:85]
    s_waitcnt lgkmcnt(0)
    v_add_lshl_u32 v78, v78, v70, 3
    v_add_lshl_u32 v79, v79, v71, 3
    v_add_lshl_u32 v80, v80, v72, 3
    v_add_lshl_u32 v81, v81, v73, 3
    v_add_lshl_u32 v82, v82, v74, 3
    v_add_lshl_u32 v83, v83, v75, 3
    v_add_lshl_u32 v84, v84, v76, 3
    v_add_lshl_u32 v85, v85, v77, 3
    s_waitcnt vmcnt(6)
    v_lshlrev_b32 v102, 2, v22
    v_lshl_or_b32 v103, v30, 16, v54
    v_lshlrev_b32 v104, 2, v23
    v_and_or_b32 v105, v30, s90, v55
    v_lshlrev_b32 v106, 2, v24
    v_lshl_or_b32 v107, v31, 16, v56
    v_lshlrev_b32 v108, 2, v25
    v_and_or_b32 v109, v31, s90, v57
    ds_write_b64 v78, v[102:103] offset:44800
    ds_write_b64 v79, v[104:105] offset:44800
    ds_write_b64 v80, v[106:107] offset:44800
    ds_write_b64 v81, v[108:109] offset:44800
    s_waitcnt vmcnt(5)
    v_lshlrev_b32 v110, 2, v26
    v_lshl_or_b32 v111, v32, 16, v58
    v_lshlrev_b32 v112, 2, v27
    v_and_or_b32 v113, v32, s90, v59
    v_lshlrev_b32 v114, 2, v28
    v_lshl_or_b32 v115, v33, 16, v60
    v_lshlrev_b32 v116, 2, v29
    v_and_or_b32 v117, v33, s90, v61
    ds_write_b64 v82, v[110:111] offset:44800
    ds_write_b64 v83, v[112:113] offset:44800
    ds_write_b64 v84, v[114:115] offset:44800
    ds_write_b64 v85, v[116:117] offset:44800
    s_mov_b64 exec, -1
    s_waitcnt vmcnt(4)
    s_branch L_BDONE
L_W7W:
    s_waitcnt vmcnt(4)
L_BDONE:
    s_mov_b32 s63, 0
L_NONCE:
    v_readfirstlane_b32 s65, v173
    v_readfirstlane_b32 s64, v172
    s_cmp_lt_i32 s65, 0
    s_cbranch_scc0 L_NONCER
    s_mov_b64 s[24:25], s[64:65]
    s_lshl_b32 s50, s64, 16
    s_and_b32 s51, s64, 0xffff0000
    s_cmp_eq_u32 s61, 7
    s_cbranch_scc1 L_HDR
L_JOIN:
    s_waitcnt lgkmcnt(0)
    s_barrier
    ds_read_b128 v[118:121], v166 offset:0
    ds_read_b128 v[122:125], v166 offset:8192
    ds_read_b128 v[126:129], v166 offset:16384
    ds_read_b128 v[130:133], v166 offset:24576
    s_mov_b64 s[64:65], vcc
    s_waitcnt lgkmcnt(3)
    v_bfi_b32 v118, v167, v118, s50
    v_bfi_b32 v120, v167, v120, s51
    buffer_store_dwordx4 v[118:121], v151, s[36:39], s68 offen sc1
    s_waitcnt lgkmcnt(2)
    v_bfi_b32 v122, v167, v122, s50
    v_bfi_b32 v124, v167, v124, s51
    s_waitcnt lgkmcnt(1)
    v_bfi_b32 v126, v167, v126, s50
    v_bfi_b32 v128, v167, v128, s51
    s_waitcnt lgkmcnt(0)
    v_bfi_b32 v130, v167, v130, s50
    v_bfi_b32 v132, v167, v132, s51
    buffer_store_dwordx4 v[122:125], v151, s[36:39], s69 offen sc1
    buffer_store_dwordx4 v[126:129], v151, s[36:39], s70 offen sc1
    s_mov_b64 exec, s[64:65]
    s_cbranch_execz L_NO4
    buffer_store_dwordx4 v[130:133], v151, s[36:39], s71 offen sc1
L_NO4:
    s_mov_b64 exec, -1
    s_mov_b32 s3, 0x7fff7fff
    v_and_b32 v30, s3, v30
    v_and_b32 v31, s3, v31
    v_and_b32 v32, s3, v32
    v_and_b32 v33, s3, v33
    v_pk_max_u16 v30, v30, v31
    v_pk_max_u16 v32, v32, v33
    v_pk_max_u16 v30, v30, v32
    v_lshlrev_b32 v31, 16, v30
    v_max_u32 v30, v30, v31
    ds_max_u32 v245, v30 offset:2176
    s_mul_i32 s3, s61, 6144
    s_add_u32 s3, s3, 114688
    v_lshl_add_u32 v174, v1, 4, s3
    ds_write_b128 v174, v[10:13] offset:0
    ds_write_b128 v174, v[10:13] offset:1024
    ds_write_b128 v174, v[10:13] offset:2048
    ds_write_b128 v174, v[10:13] offset:3072
    ds_write_b128 v174, v[10:13] offset:4096
    ds_write_b128 v174, v[10:13] offset:5120
    s_waitcnt vmcnt(5) lgkmcnt(0)
    s_cmp_eq_u32 s61, 7
    s_cbranch_scc1 L_W4
    s_cmp_eq_u64 s[64:65], 0
    s_cbranch_scc1 L_W3
    s_waitcnt vmcnt(4)
    s_branch L_W4
L_W3:
    s_waitcnt vmcnt(3)
L_W4:
    s_barrier
    s_cmp_eq_u32 s61, 5
    s_cbranch_scc1 L_FLAG
L_NOFLAG:
    s_and_b32 s19, s61, 1
    s_bfe_u32 s20, s61, 0x10001
    s_mul_i32 s3, s20, 28
    v_lshrrev_b32 v158, 3, v161
    v_sub_u32 v158, v161, v158
    v_add_u32 v158, s3, v158
    v_and_b32 v159, 7, v158
    v_lshlrev_b32 v158, 7, v158
    v_lshl_add_u32 v246, v160, 3, v158
    v_add_u32 v158, 103936, v158
    v_xor_b32 v174, v159, v160
    v_lshl_add_u32 v150, v174, 4, v158
    v_xor_b32 v151, 32, v150
    v_xor_b32 v152, 64, v150
    v_xor_b32 v153, 96, v150
    ds_read_b128 v[134:137], v150
    ds_read_b128 v[138:141], v151
    ds_read_b128 v[142:145], v152
    ds_read_b128 v[146:149], v153
    s_lshl_b32 s3, s19, 6
    s_add_u32 s3, s3, 79360
    v_add_u32 v162, s3, v162
    v_mov_b32 v168, v159
    v_mov_b32 v169, v158
    s_cmp_ge_u32 s61, 4
    s_cbranch_scc1 L_NOA
    ds_read_b64_tr_b16 v[46:47], v162 offset:16384
    ds_read_b64_tr_b16 v[48:49], v162 offset:16896
    ds_read_b64_tr_b16 v[50:51], v162 offset:18432
    ds_read_b64_tr_b16 v[52:53], v162 offset:18944
    ds_read_b64_tr_b16 v[54:55], v162 offset:20480
    ds_read_b64_tr_b16 v[56:57], v162 offset:20992
    ds_read_b64_tr_b16 v[58:59], v162 offset:22528
    ds_read_b64_tr_b16 v[60:61], v162 offset:23040
    s_lshl_b32 s3, s20, 12
    s_lshl_b32 s98, s19, 9
    s_add_u32 s3, s3, s98
    v_lshlrev_b32 v174, 4, v161
    v_lshl_add_u32 v174, v160, 3, v174
    v_add_u32 v174, s3, v174
    s_mov_b32 s64, 0xbfb8aa3b
    s_mov_b32 s65, 0xbfb8aa3b
    s_waitcnt lgkmcnt(0)
    v_mfma_f32_32x32x16_bf16 v[14:29], v[134:137], v[46:49], 0
    v_mfma_f32_32x32x16_bf16 v[14:29], v[138:141], v[50:53], v[14:29]
    v_mfma_f32_32x32x16_bf16 v[14:29], v[142:145], v[54:57], v[14:29]
    v_mfma_f32_32x32x16_bf16 v[14:29], v[146:149], v[58:61], v[14:29]
    s_nop 15
    v_pk_mul_f32 v[14:15], v[14:15], s[64:65]
    v_pk_mul_f32 v[16:17], v[16:17], s[64:65]
    v_pk_mul_f32 v[18:19], v[18:19], s[64:65]
    v_pk_mul_f32 v[20:21], v[20:21], s[64:65]
    v_pk_mul_f32 v[22:23], v[22:23], s[64:65]
    v_pk_mul_f32 v[24:25], v[24:25], s[64:65]
    v_pk_mul_f32 v[26:27], v[26:27], s[64:65]
    v_pk_mul_f32 v[28:29], v[28:29], s[64:65]
    v_max_f32 v175, |v14|, |v15|
    v_max3_f32 v175, v175, |v16|, |v17|
    v_max3_f32 v175, v175, |v18|, |v19|
    v_max3_f32 v175, v175, |v20|, |v21|
    v_max3_f32 v175, v175, |v22|, |v23|
    v_max3_f32 v175, v175, |v24|, |v25|
    v_max3_f32 v175, v175, |v26|, |v27|
    v_max3_f32 v175, v175, |v28|, |v29|
    v_cvt_pk_bf16_f32 v14, v14, v15
    v_cvt_pk_bf16_f32 v15, v16, v17
    v_cvt_pk_bf16_f32 v16, v18, v19
    v_cvt_pk_bf16_f32 v17, v20, v21
    v_cvt_pk_bf16_f32 v18, v22, v23
    v_cvt_pk_bf16_f32 v19, v24, v25
    v_cvt_pk_bf16_f32 v20, v26, v27
    v_cvt_pk_bf16_f32 v21, v28, v29
    ds_max_u32 v245, v175 offset:2432
    ds_write_b64 v174, v[14:15] offset:18688
    ds_write_b64 v174, v[16:17] offset:19712
    ds_write_b64 v174, v[18:19] offset:20736
    s_cmp_ge_u32 s61, 2
    s_cbranch_scc1 L_TABD
    ds_write_b64 v174, v[20:21] offset:21760
    s_branch L_TABD
L_NOA:
    s_cmp_lg_u32 s61, 6
    s_cbranch_scc1 L_TABD
    s_mov_b32 s3, 0xbfb8aa3b
    v_lshlrev_b32 v34, 16, v34
    v_lshlrev_b32 v35, 16, v35
    v_lshlrev_b32 v36, 16, v36
    v_mul_f32 v34, s3, v34
    v_mul_f32 v35, s3, v35
    ds_write_b32 v237, v36 offset:18432
    v_and_b32 v174, 0x7fffffff, v34
    v_and_b32 v175, 0x7fffffff, v35
    ds_max_u32 v245, v174 offset:2560
    ds_max_u32 v245, v175 offset:2688
    v_cvt_pk_bf16_f32 v14, v34, v35
    v_lshlrev_b32 v174, 16, v14
    v_and_b32 v175, 0xffff0000, v14
    v_sub_f32 v34, v34, v174
    v_sub_f32 v35, v35, v175
    v_cvt_pk_bf16_f32 v15, v34, v35
    v_mov_b32 v16, 0
    v_mov_b32 v17, 0
    v_lshlrev_b32 v174, 4, v1
    ds_write_b128 v174, v[14:17] offset:25856
L_TABD:
    v_pk_mov_b32 v[176:177], v[10:11], v[10:11]
    v_pk_mov_b32 v[178:179], v[10:11], v[10:11]
    v_pk_mov_b32 v[180:181], v[10:11], v[10:11]
    v_pk_mov_b32 v[182:183], v[10:11], v[10:11]
    v_mov_b32 v238, 0
    s_mov_b32 s62, 0
    s_mov_b32 s96, 0
    s_mov_b32 s22, 0x01111111
    s_mov_b32 s23, 0x01111111
    s_mov_b32 s46, 16
    s_mov_b32 s99, 0
    s_mov_b32 s27, 32
    s_mov_b32 s47, 0xffffaf00
    v_mov_b32 v164, s50
    v_mov_b32 v165, 0x3800
    v_mov_b32 v166, s51
    v_mov_b32 v167, 0x3800
    v_pk_mov_b32 v[102:103], v[164:165], v[164:165] op_sel:[0,1]
    v_pk_mov_b32 v[104:105], v[166:167], v[166:167] op_sel:[0,1]
    v_pk_mov_b32 v[106:107], v[164:165], v[164:165] op_sel:[0,1]
    v_pk_mov_b32 v[108:109], v[166:167], v[166:167] op_sel:[0,1]
    v_pk_mov_b32 v[110:111], v[164:165], v[164:165] op_sel:[0,1]
    v_pk_mov_b32 v[112:113], v[166:167], v[166:167] op_sel:[0,1]
    v_pk_mov_b32 v[114:115], v[164:165], v[164:165] op_sel:[0,1]
    v_pk_mov_b32 v[116:117], v[166:167], v[166:167] op_sel:[0,1]
    v_pk_mov_b32 v[118:119], v[164:165], v[164:165] op_sel:[0,1]
    v_pk_mov_b32 v[120:121], v[166:167], v[166:167] op_sel:[0,1]
    v_pk_mov_b32 v[122:123], v[164:165], v[164:165] op_sel:[0,1]
    v_pk_mov_b32 v[124:125], v[166:167], v[166:167] op_sel:[0,1]
    v_pk_mov_b32 v[126:127], v[164:165], v[164:165] op_sel:[0,1]
    v_pk_mov_b32 v[128:129], v[166:167], v[166:167] op_sel:[0,1]
    v_pk_mov_b32 v[130:131], v[164:165], v[164:165] op_sel:[0,1]
    v_pk_mov_b32 v[132:133], v[166:167], v[166:167] op_sel:[0,1]
    s_waitcnt lgkmcnt(0)
    s_barrier
    buffer_load_dwordx4 v[86:89], v223, s[36:39], s14 offen sc1
    buffer_load_dwordx4 v[90:93], v223, s[36:39], s15 offen sc1
    buffer_load_dwordx4 v[94:97], v223, s[36:39], s16 offen sc1
    buffer_load_dwordx4 v[98:101], v223, s[36:39], s17 offen sc1
    ds_read_b64_tr_b16 v[46:47], v162 offset:0
    ds_read_b64_tr_b16 v[48:49], v162 offset:512
    ds_read_b64_tr_b16 v[50:51], v162 offset:2048
    ds_read_b64_tr_b16 v[52:53], v162 offset:2560
    ds_read_b64_tr_b16 v[54:55], v162 offset:4096
    ds_read_b64_tr_b16 v[56:57], v162 offset:4608
    ds_read_b64_tr_b16 v[58:59], v162 offset:6144
    ds_read_b64_tr_b16 v[60:61], v162 offset:6656
    ds_read_b64_tr_b16 v[184:185], v162 offset:8192
    ds_read_b64_tr_b16 v[186:187], v162 offset:8704
    ds_read_b64_tr_b16 v[188:189], v162 offset:10240
    ds_read_b64_tr_b16 v[190:191], v162 offset:10752
    ds_read_b64_tr_b16 v[192:193], v162 offset:12288
    ds_read_b64_tr_b16 v[194:195], v162 offset:12800
    ds_read_b64_tr_b16 v[196:197], v162 offset:14336
    ds_read_b64_tr_b16 v[198:199], v162 offset:14848
    s_lshr_b32 s21, s61, 2
    s_lshl_b32 s3, s19, 1
    s_add_u32 s3, s3, s21
    s_lshl_b32 s3, s3, 1
    v_xor_b32 v174, s3, v168
    v_lshl_add_u32 v174, v174, 4, v169
    v_lshl_add_u32 v174, v160, 3, v174
    v_xor_b32 v175, 16, v174
    ds_read_b64 v[216:217], v174
    ds_read_b64 v[218:219], v175
    s_lshl_b32 s3, s3, 4
    s_lshl_b32 s26, s101, 7
    s_add_u32 s26, s26, s3
    s_mov_b32 s18, s101
    s_waitcnt lgkmcnt(10)
    v_mfma_f32_32x32x16_bf16 v[200:215], v[46:49], v[134:137], 0
    v_mfma_f32_32x32x16_bf16 v[200:215], v[50:53], v[138:141], v[200:215]
    v_mfma_f32_32x32x16_bf16 v[200:215], v[54:57], v[142:145], v[200:215]
    v_mfma_f32_32x32x16_bf16 v[200:215], v[58:61], v[146:149], v[200:215]
    s_lshl_b32 s3, s61, 7
    s_add_u32 s3, s3, 14332
    v_add_u32 v174, s3, v237
    ds_read_b32 v251, v174
    v_lshrrev_b32 v247, 3, v1
    v_and_b32 v248, 7, v1
    v_mul_u32_u24 v249, 144, v247
    v_lshl_add_u32 v249, v248, 4, v249
    v_lshlrev_b32 v248, 5, v248
    v_lshl_add_u32 v247, v247, 8, v248
    v_and_b32 v248, 0x7c, v237
    s_mul_i32 s3, s61, 1152
    s_add_u32 s3, s3, 79360
    v_add_u32 v249, s3, v249
    s_bfe_u32 s3, s61, 0x10001
    s_mul_i32 s3, s3, 4608
    s_add_u32 s3, s3, 79360
    v_and_b32 v250, 31, v1
    v_mul_u32_u24 v250, 144, v250
    v_add3_u32 v250, v250, v236, s3
    s_mul_i32 s12, s61, 7
    s_add_u32 s12, s12, s18
    s_sub_u32 s3, 12500, s12
    v_lshrrev_b32 v252, 2, v1
    v_cmp_gt_i32 vcc, s3, v252
    v_sub_u32 v252, v1, v252
    v_lshlrev_b32 v252, 1, v252
    s_mul_i32 s12, s12, 6
    s_add_u32 s12, s12, 1599998
    s_cmp_eq_u32 s61, 7
    s_cselect_b32 s3, 0, 0x0eeeeeee
    s_and_b32 s13, vcc_lo, s3
    v_lshlrev_b32 v158, 17, v0
    v_add_u32 v158, 0x3b004000, v158
    v_lshlrev_b32 v159, 2, v0
    v_cmp_gt_u32 vcc, 64, v0
    v_add_u32 v14, 0x0, v158
    v_add_u32 v15, 0x18000, v14
    v_add_u32 v16, 0x80000000, v158
    v_add_u32 v17, 0x18000, v16
    v_add_u32 v18, 0x4000000, v158
    v_add_u32 v19, 0x18000, v18
    v_add_u32 v20, 0x84000000, v158
    v_add_u32 v21, 0x18000, v20
    v_add_u32 v22, 0x8000000, v158
    v_add_u32 v23, 0x18000, v22
    v_add_u32 v24, 0x88000000, v158
    v_add_u32 v25, 0x18000, v24
    v_exp_f32 v46, v14
    v_exp_f32 v47, v15
    v_exp_f32 v48, v16
    v_exp_f32 v49, v17
    v_exp_f32 v50, v18
    v_exp_f32 v51, v19
    v_exp_f32 v52, v20
    v_exp_f32 v53, v21
    v_exp_f32 v54, v22
    v_exp_f32 v55, v23
    v_exp_f32 v56, v24
    v_exp_f32 v57, v25
    v_pk_add_f32 v[46:47], v[46:47], 1.0 op_sel_hi:[1,0]
    v_pk_add_f32 v[48:49], v[48:49], 1.0 op_sel_hi:[1,0]
    v_pk_add_f32 v[50:51], v[50:51], 1.0 op_sel_hi:[1,0]
    v_pk_add_f32 v[52:53], v[52:53], 1.0 op_sel_hi:[1,0]
    v_pk_add_f32 v[54:55], v[54:55], 1.0 op_sel_hi:[1,0]
    v_pk_add_f32 v[56:57], v[56:57], 1.0 op_sel_hi:[1,0]
    v_rcp_f32 v46, v46
    v_rcp_f32 v47, v47
    v_rcp_f32 v48, v48
    v_rcp_f32 v49, v49
    v_rcp_f32 v50, v50
    v_rcp_f32 v51, v51
    v_rcp_f32 v52, v52
    v_rcp_f32 v53, v53
    v_rcp_f32 v54, v54
    v_rcp_f32 v55, v55
    v_rcp_f32 v56, v56
    v_rcp_f32 v57, v57
    v_pk_mul_f32 v[46:47], v[46:47], v[14:15]
    v_pk_mul_f32 v[48:49], v[48:49], v[16:17]
    v_pk_mul_f32 v[50:51], v[50:51], v[18:19]
    v_pk_mul_f32 v[52:53], v[52:53], v[20:21]
    v_pk_mul_f32 v[54:55], v[54:55], v[22:23]
    v_pk_mul_f32 v[56:57], v[56:57], v[24:25]
    v_cvt_pk_bf16_f32 v46, v46, v47
    v_cvt_pk_bf16_f32 v47, v48, v49
    v_cvt_pk_bf16_f32 v48, v50, v51
    v_cvt_pk_bf16_f32 v49, v52, v53
    v_cvt_pk_bf16_f32 v50, v54, v55
    v_cvt_pk_bf16_f32 v51, v56, v57
    v_add_u32 v158, 75008, v159
    ds_write_b32 v159, v46 offset:9472
    ds_write_b32 v158, v47 offset:0
    ds_write_b32 v159, v48 offset:11520
    ds_write_b32 v158, v49 offset:2048
    s_mov_b64 exec, vcc
    ds_write_b32 v159, v50 offset:13568
    ds_write_b32 v158, v51 offset:4096
    s_mov_b64 exec, -1
    v_lshlrev_b32 v158, 3, v0
    v_add_u32 v158, 10368, v158
    v_add_u32 v159, 0xffffff80, v158
    v_mul_u32_u24 v14, 0x10001, v159
    v_add_u32 v14, 0x20000, v14
    v_add_u32 v15, 0x20002, v14
    v_add_u32 v16, 0x40004, v14
    v_add_u32 v17, 0x60006, v14
    v_lshlrev_b32 v159, 4, v0
    v_add_u32 v159, 0, v159
    ds_write_b128 v159, v[14:17] offset:0
    s_nop 0
    v_add_u32 v14, 0x10001000, v14
    v_add_u32 v15, 0x10001000, v15
    v_add_u32 v16, 0x10001000, v16
    v_add_u32 v17, 0x10001000, v17
    v_cmp_gt_u32 vcc, 80, v0
    s_nop 1
    s_mov_b64 exec, vcc
    ds_write_b128 v159, v[14:17] offset:8192
    s_mov_b64 exec, -1
    v_cmp_gt_u32 vcc, 32, v0
    v_lshlrev_b32 v159, 4, v0
    s_mov_b64 exec, vcc
    ds_write_b128 v159, v[10:13] offset:44800
    s_mov_b64 exec, -1
L_POLL:
    s_waitcnt vmcnt(0)
    v_cmp_ne_u64 s[64:65], s[24:25], v[88:89]
    v_cmp_ne_u64 s[66:67], s[24:25], v[92:93]
    v_cmp_ne_u64 s[68:69], s[24:25], v[96:97]
    v_cmp_ne_u64 s[70:71], s[24:25], v[100:101]
    s_bitcmp1_b32 s60, 0
    s_cselect_b64 vcc, -1, 0
    s_or_b64 s[64:65], s[64:65], s[66:67]
    s_or_b64 s[68:69], s[68:69], s[70:71]
    s_or_b64 s[64:65], s[64:65], s[68:69]
    s_cbranch_scc1 L_POLLR
    s_mul_i32 s14, s61, 872448
    s_add_u32 s14, s14, 2457600
    s_add_u32 s15, s14, 218112
    s_add_u32 s16, s14, 436224
    s_add_u32 s17, s14, 654336
    v_cndmask_b32 v239, v86, v87, vcc
    v_cndmask_b32 v240, v90, v91, vcc
    v_cndmask_b32 v241, v94, v95, vcc
    v_cndmask_b32 v242, v98, v99, vcc
    s_cmp_eq_u32 s61, 7
    s_cbranch_scc1 L_FLD
L_FLDD:
    s_mov_b32 s96, 0
L_ROUND:
    v_add_u32_sdwa v134, v243, v239 dst_sel:DWORD dst_unused:UNUSED_PAD src0_sel:DWORD src1_sel:WORD_0
    v_sub_u32_sdwa v138, v239, v244 dst_sel:DWORD dst_unused:UNUSED_PAD src0_sel:WORD_1 src1_sel:DWORD
    v_add_u32_sdwa v135, v243, v240 dst_sel:DWORD dst_unused:UNUSED_PAD src0_sel:DWORD src1_sel:WORD_0
    v_sub_u32_sdwa v139, v240, v244 dst_sel:DWORD dst_unused:UNUSED_PAD src0_sel:WORD_1 src1_sel:DWORD
    v_add_u32_sdwa v136, v243, v241 dst_sel:DWORD dst_unused:UNUSED_PAD src0_sel:DWORD src1_sel:WORD_0
    v_sub_u32_sdwa v140, v241, v244 dst_sel:DWORD dst_unused:UNUSED_PAD src0_sel:WORD_1 src1_sel:DWORD
    v_add_u32_sdwa v137, v243, v242 dst_sel:DWORD dst_unused:UNUSED_PAD src0_sel:DWORD src1_sel:WORD_0
    v_sub_u32_sdwa v141, v242, v244 dst_sel:DWORD dst_unused:UNUSED_PAD src0_sel:WORD_1 src1_sel:DWORD
    v_cmp_lt_i32 s[64:65], 0, v138
    v_cmp_lt_i32 s[72:73], 0, v139
    v_cmp_lt_i32 s[80:81], 0, v140
    v_cmp_lt_i32 s[88:89], 0, v141
    v_cmp_lt_i32 s[68:69], s46, v138
    v_cmp_lt_i32 s[76:77], s46, v139
    v_cmp_lt_i32 s[84:85], s46, v140
    v_cmp_lt_i32 s[92:93], s46, v141
    s_mov_b64 exec, s[64:65]
    buffer_load_dwordx4 v[102:105], v134, s[36:39], s14 offen offset:0 sc1
    s_mov_b64 exec, s[72:73]
    buffer_load_dwordx4 v[110:113], v135, s[36:39], s15 offen offset:0 sc1
    s_mov_b64 exec, s[80:81]
    buffer_load_dwordx4 v[118:121], v136, s[36:39], s16 offen offset:0 sc1
    s_mov_b64 exec, s[88:89]
    buffer_load_dwordx4 v[126:129], v137, s[36:39], s17 offen offset:0 sc1
    s_mov_b64 exec, s[68:69]
    buffer_load_dwordx4 v[106:109], v134, s[36:39], s14 offen offset:128 sc1
    s_mov_b64 exec, s[76:77]
    buffer_load_dwordx4 v[114:117], v135, s[36:39], s15 offen offset:128 sc1
    s_mov_b64 exec, s[84:85]
    buffer_load_dwordx4 v[122:125], v136, s[36:39], s16 offen offset:128 sc1
    s_mov_b64 exec, s[92:93]
    buffer_load_dwordx4 v[130:133], v137, s[36:39], s17 offen offset:128 sc1
    s_mov_b64 exec, -1
    v_cmp_lt_i32 s[66:67], 1, v138
    v_cmp_lt_i32 s[70:71], 17, v138
    v_cmp_lt_i32 s[74:75], 1, v139
    v_cmp_lt_i32 s[78:79], 17, v139
    v_cmp_lt_i32 s[82:83], 1, v140
    v_cmp_lt_i32 s[86:87], 17, v140
    v_cmp_lt_i32 s[90:91], 1, v141
    v_cmp_lt_i32 s[94:95], 17, v141
    v_max_i32 v138, v138, v139
    v_max3_i32 v138, v138, v140, v141
    v_cmp_lt_i32 vcc, s27, v138
    v_mov_b32 v71, 1
    v_mov_b32 v72, 0x3800
    s_mov_b64 exec, vcc
    ds_write_b32 v10, v71 offset:15352
    s_mov_b64 exec, -1
    s_mov_b32 s21, 0
    s_cmp_lg_u64 s[68:69], 0
    s_addc_u32 s21, s21, s21
    s_cmp_lg_u64 s[76:77], 0
    s_addc_u32 s21, s21, s21
    s_cmp_lg_u64 s[84:85], 0
    s_addc_u32 s21, s21, s21
    s_cmp_lg_u64 s[92:93], 0
    s_addc_u32 s21, s21, s21
    v_pk_mov_b32 v[150:151], v[10:11], v[10:11]
    v_pk_mov_b32 v[152:153], v[10:11], v[10:11]
    v_pk_mov_b32 v[154:155], v[10:11], v[10:11]
    v_pk_mov_b32 v[156:157], v[10:11], v[10:11]
    v_pk_mov_b32 v[78:79], v[10:11], v[10:11]
    v_pk_mov_b32 v[80:81], v[10:11], v[10:11]
    v_pk_mov_b32 v[82:83], v[10:11], v[10:11]
    v_pk_mov_b32 v[84:85], v[10:11], v[10:11]
    v_lshrrev_b32 v73, 5, v1
    v_lshl_add_u32 v73, v73, 9, v245
    s_lshl_b32 s3, s61, 1
    v_mov_b32 v74, s3
    v_mov_b32 v75, 79360
    s_lshl_b32 s3, s61, 4
    v_mov_b32 v77, s3
    s_cmp_eq_u32 s61, 7
    s_cselect_b32 s3, 64, 0
    v_mov_b32 v76, s3
    s_cmp_eq_u32 s61, 7
    s_cbranch_scc1 L_GUARD
    s_cmp_lg_u32 s99, 0
    s_cbranch_scc1 L_GUARDD
    s_mov_b32 s99, 1
    v_lshlrev_b32 v158, 3, v0
    v_add_u32 v158, 33024, v158
    v_add_u32 v159, 0xffffff80, v158
    v_mul_u32_u24 v14, 0x10001, v159
    v_add_u32 v14, 0x20000, v14
    v_add_u32 v15, 0x20002, v14
    v_add_u32 v16, 0x40004, v14
    v_add_u32 v17, 0x60006, v14
    v_lshlrev_b32 v159, 4, v0
    v_add_u32 v159, 45312, v159
    ds_write_b128 v159, v[14:17] offset:0
    s_nop 0
    v_add_u32 v14, 0xe000e00, v14
    v_add_u32 v15, 0xe000e00, v15
    v_add_u32 v16, 0xe000e00, v16
    v_add_u32 v17, 0xe000e00, v17
    ds_write_b128 v159, v[14:17] offset:7168
    s_nop 0
    v_add_u32 v14, 0xe000e00, v14
    v_add_u32 v15, 0xe000e00, v15
    v_add_u32 v16, 0xe000e00, v16
    v_add_u32 v17, 0xe000e00, v17
    ds_write_b128 v159, v[14:17] offset:14336
    s_nop 0
    v_add_u32 v14, 0xe000e00, v14
    v_add_u32 v15, 0xe000e00, v15
    v_add_u32 v16, 0xe000e00, v16
    v_add_u32 v17, 0xe000e00, v17
    ds_write_b128 v159, v[14:17] offset:21504
    s_nop 0
    v_add_u32 v14, 0xe000e00, v14
    v_add_u32 v15, 0xe000e00, v15
    v_add_u32 v16, 0xe000e00, v16
    v_add_u32 v17, 0xe000e00, v17
    v_cmp_gt_u32 vcc, 64, v0
    s_nop 1
    s_mov_b64 exec, vcc
    ds_write_b128 v159, v[14:17] offset:28672
    s_mov_b64 exec, -1
L_GUARDD:
    s_waitcnt vmcnt(7)
    v_cndmask_b32 v105, v72, v105, s[66:67]
    v_xor_b32 v102, s50, v102
    v_xor_b32 v104, s51, v104
    v_bfe_u32 v86, v103, 11, 3
    v_or_b32 v70, v102, v104
    v_bfe_u32 v87, v105, 11, 3
    v_lshl_add_u32 v86, v86, 7, v245
    v_lshl_add_u32 v87, v87, 7, v245
    s_waitcnt vmcnt(6)
    v_cndmask_b32 v113, v72, v113, s[74:75]
    v_xor_b32 v110, s50, v110
    v_xor_b32 v112, s51, v112
    v_bfe_u32 v90, v111, 11, 3
    v_or3_b32 v70, v70, v110, v112
    v_bfe_u32 v91, v113, 11, 3
    v_lshl_add_u32 v90, v90, 7, v245
    v_lshl_add_u32 v91, v91, 7, v245
    s_waitcnt vmcnt(5)
    v_cndmask_b32 v121, v72, v121, s[82:83]
    v_xor_b32 v118, s50, v118
    v_xor_b32 v120, s51, v120
    v_bfe_u32 v94, v119, 11, 3
    v_or3_b32 v70, v70, v118, v120
    v_bfe_u32 v95, v121, 11, 3
    v_lshl_add_u32 v94, v94, 7, v245
    v_lshl_add_u32 v95, v95, 7, v245
    s_waitcnt vmcnt(4)
    v_cndmask_b32 v129, v72, v129, s[90:91]
    v_xor_b32 v126, s50, v126
    v_xor_b32 v128, s51, v128
    v_bfe_u32 v98, v127, 11, 3
    v_or3_b32 v70, v70, v126, v128
    v_bfe_u32 v99, v129, 11, 3
    v_lshl_add_u32 v98, v98, 7, v245
    v_lshl_add_u32 v99, v99, 7, v245
    s_waitcnt vmcnt(3)
    v_cndmask_b32 v109, v72, v109, s[70:71]
    v_xor_b32 v106, s50, v106
    v_xor_b32 v108, s51, v108
    v_bfe_u32 v88, v107, 11, 3
    v_or3_b32 v70, v70, v106, v108
    v_bfe_u32 v89, v109, 11, 3
    v_lshl_add_u32 v88, v88, 7, v245
    v_lshl_add_u32 v89, v89, 7, v245
    s_waitcnt vmcnt(2)
    v_cndmask_b32 v117, v72, v117, s[78:79]
    v_xor_b32 v114, s50, v114
    v_xor_b32 v116, s51, v116
    v_bfe_u32 v92, v115, 11, 3
    v_or3_b32 v70, v70, v114, v116
    v_bfe_u32 v93, v117, 11, 3
    v_lshl_add_u32 v92, v92, 7, v245
    v_lshl_add_u32 v93, v93, 7, v245
    s_waitcnt vmcnt(1)
    v_cndmask_b32 v125, v72, v125, s[86:87]
    v_xor_b32 v122, s50, v122
    v_xor_b32 v124, s51, v124
    v_bfe_u32 v96, v123, 11, 3
    v_or3_b32 v70, v70, v122, v124
    v_bfe_u32 v97, v125, 11, 3
    v_lshl_add_u32 v96, v96, 7, v245
    v_lshl_add_u32 v97, v97, 7, v245
    s_waitcnt vmcnt(0)
    v_cndmask_b32 v133, v72, v133, s[94:95]
    v_xor_b32 v130, s50, v130
    v_xor_b32 v132, s51, v132
    v_bfe_u32 v100, v131, 11, 3
    v_or3_b32 v70, v70, v130, v132
    v_bfe_u32 v101, v133, 11, 3
    v_cmp_lt_u32 vcc, 0xffff, v70
    v_lshl_add_u32 v100, v100, 7, v245
    v_lshl_add_u32 v101, v101, 7, v245
    s_nop 1
    s_cbranch_vccnz L_RETRY
    ds_add_rtn_u32 v46, v86, v71
    ds_add_rtn_u32 v47, v87, v71
    ds_add_rtn_u32 v48, v88, v71
    ds_add_rtn_u32 v49, v89, v71
    ds_add_rtn_u32 v50, v90, v71
    ds_add_rtn_u32 v51, v91, v71
    ds_add_rtn_u32 v52, v92, v71
    ds_add_rtn_u32 v53, v93, v71
    ds_add_rtn_u32 v54, v94, v71
    ds_add_rtn_u32 v55, v95, v71
    ds_add_rtn_u32 v56, v96, v71
    ds_add_rtn_u32 v57, v97, v71
    ds_add_rtn_u32 v58, v98, v71
    ds_add_rtn_u32 v59, v99, v71
    ds_add_rtn_u32 v60, v100, v71
    ds_add_rtn_u32 v61, v101, v71
    s_waitcnt lgkmcnt(0)
    s_barrier
    s_cmp_lg_u32 s61, 0
    s_cbranch_scc1 L_NOPLAN
    ds_read2_b32 v[30:31], v73 offset0:0 offset1:32
    ds_read2_b32 v[32:33], v73 offset0:64 offset1:96
    s_waitcnt lgkmcnt(0)
    v_lshl_or_b32 v34, v31, 16, v30
    v_lshl_or_b32 v35, v33, 16, v32
    v_pk_mov_b32 v[36:37], v[34:35], v[34:35] op_sel:[0,1]
    s_nop 1
    v_add_u32_dpp v36, v36, v36 row_shr:1 row_mask:0xf bank_mask:0xf bound_ctrl:0
    v_add_u32_dpp v37, v37, v37 row_shr:1 row_mask:0xf bank_mask:0xf bound_ctrl:0
    s_nop 0
    v_add_u32_dpp v36, v36, v36 row_shr:2 row_mask:0xf bank_mask:0xf bound_ctrl:0
    v_add_u32_dpp v37, v37, v37 row_shr:2 row_mask:0xf bank_mask:0xf bound_ctrl:0
    s_nop 0
    v_add_u32_dpp v36, v36, v36 row_shr:4 row_mask:0xf bank_mask:0xf bound_ctrl:0
    v_add_u32_dpp v37, v37, v37 row_shr:4 row_mask:0xf bank_mask:0xf bound_ctrl:0
    s_nop 0
    v_add_u32_dpp v36, v36, v36 row_shr:8 row_mask:0xf bank_mask:0xf bound_ctrl:0
    v_add_u32_dpp v37, v37, v37 row_shr:8 row_mask:0xf bank_mask:0xf bound_ctrl:0
    s_nop 0
    v_add_u32_dpp v36, v36, v36 row_bcast:15 row_mask:0xa bank_mask:0xf
    v_add_u32_dpp v37, v37, v37 row_bcast:15 row_mask:0xa bank_mask:0xf
    s_nop 1
    v_readlane_b32 s5, v36, 31
    v_readlane_b32 s7, v37, 31
    v_readlane_b32 s9, v36, 63
    v_readlane_b32 s10, v37, 63
    v_sub_u32 v36, v36, v34
    v_sub_u32 v37, v37, v35
    s_and_b32 s10, s10, 0xffff
    v_writelane_b32 v38, s5, 4
    s_add_u32 s64, s5, 0x1f001f
    s_and_b32 s64, s64, 0xffe0ffe0
    v_writelane_b32 v38, s7, 5
    s_add_u32 s65, s7, 0x1f001f
    s_and_b32 s65, s65, 0xffe0ffe0
    v_writelane_b32 v38, s9, 6
    s_add_u32 s66, s9, 0x1f001f
    s_and_b32 s66, s66, 0xffe0ffe0
    v_writelane_b32 v38, s10, 7
    s_add_u32 s67, s10, 0x1f001f
    s_and_b32 s67, s67, 0xffe0
    s_lshl_b32 s68, s64, 16
    s_mul_i32 s3, s64, 0x10001
    s_lshr_b32 s72, s3, 16
    s_mul_i32 s69, s72, 0x10001
    s_lshl_b32 s3, s65, 16
    s_add_u32 s69, s69, s3
    s_add_u32 s19, s68, 0x4d804d80
    s_add_u32 s20, s69, 0x4d804d80
    v_writelane_b32 v38, s68, 0
    v_writelane_b32 v38, s69, 1
    s_mov_b32 exec_hi, 0
    v_add_u32 v36, s19, v36
    v_add_u32 v37, s20, v37
    s_mul_i32 s3, s65, 0x10001
    s_lshr_b32 s3, s3, 16
    s_add_u32 s72, s72, s3
    s_mul_i32 s70, s72, 0x10001
    s_lshl_b32 s3, s66, 16
    s_add_u32 s70, s70, s3
    s_mul_i32 s3, s66, 0x10001
    s_lshr_b32 s3, s3, 16
    s_add_u32 s71, s72, s3
    s_add_u32 s19, s70, 0x4d804d80
    s_add_u32 s20, s71, 0xc0004d80
    s_not_b64 exec, exec
    v_add_u32 v36, s19, v36
    v_add_u32 v37, s20, v37
    s_mov_b64 exec, -1
    ds_write_b16 v73, v36 offset:1024
    ds_write_b16_d16_hi v73, v36 offset:1152
    ds_write_b16 v73, v37 offset:1280
    ds_write_b16_d16_hi v73, v37 offset:1408
    s_add_u32 s59, s71, s67
    s_pack_ll_b32_b16 s3, s71, s59
    v_writelane_b32 v38, s70, 2
    v_writelane_b32 v38, s3, 3
    v_writelane_b32 v38, s59, 13
    s_mov_b64 exec, 0x20ff
    ds_write_b32 v237, v38 offset:15296
    s_mov_b64 exec, -1
    s_waitcnt lgkmcnt(0)
L_NOPLAN:
    s_barrier
    ds_read_b128 v[30:33], v10 offset:15344
    ds_read_u16 v34, v74 offset:15296
    ds_read_u16 v35, v74 offset:15312
    ds_read_u16 v86, v86 offset:1024
    ds_read_u16 v87, v87 offset:1024
    ds_read_u16 v90, v90 offset:1024
    ds_read_u16 v91, v91 offset:1024
    ds_read_u16 v94, v94 offset:1024
    ds_read_u16 v95, v95 offset:1024
    ds_read_u16 v98, v98 offset:1024
    ds_read_u16 v99, v99 offset:1024
    ds_read_u16 v88, v88 offset:1024
    ds_read_u16 v89, v89 offset:1024
    ds_read_u16 v92, v92 offset:1024
    ds_read_u16 v93, v93 offset:1024
    s_waitcnt lgkmcnt(12)
    v_readfirstlane_b32 s3, v30
    v_readfirstlane_b32 s59, v31
    v_readfirstlane_b32 s63, v32
    v_readfirstlane_b32 s48, v33
    v_add3_u32 v70, v34, v35, v1
    v_sub_u32 v35, 0, v35
    s_or_b32 s59, s59, s3
    s_cmp_gt_u32 s59, 4320
    s_cbranch_scc1 L_SHRINK
L_FITS:
    ds_read_u16 v96, v96 offset:1024
    ds_read_u16 v97, v97 offset:1024
    ds_read_u16 v100, v100 offset:1024
    ds_read_u16 v101, v101 offset:1024
    v_lshl_add_u32 v70, v70, 2, v75
    v_and_or_b32 v35, v35, 31, v76
    v_mov_b32 v71, 0x738
    s_waitcnt lgkmcnt(8)
    v_cmp_gt_u32 vcc, v35, v1
    v_add_lshl_u32 v86, v86, v46, 2
    v_add_lshl_u32 v87, v87, v47, 2
    v_add_lshl_u32 v90, v90, v50, 2
    v_add_lshl_u32 v91, v91, v51, 2
    v_add_lshl_u32 v94, v94, v54, 2
    v_add_lshl_u32 v95, v95, v55, 2
    v_add_lshl_u32 v98, v98, v58, 2
    v_add_lshl_u32 v99, v99, v59, 2
    ds_write2st64_b32 v86, v102, v103 offset0:0 offset1:69
    ds_write2st64_b32 v87, v104, v105 offset0:0 offset1:69
    ds_write2st64_b32 v90, v110, v111 offset0:0 offset1:69
    ds_write2st64_b32 v91, v112, v113 offset0:0 offset1:69
    ds_write2st64_b32 v94, v118, v119 offset0:0 offset1:69
    ds_write2st64_b32 v95, v120, v121 offset0:0 offset1:69
    ds_write2st64_b32 v98, v126, v127 offset0:0 offset1:69
    ds_write2st64_b32 v99, v128, v129 offset0:0 offset1:69
    s_waitcnt lgkmcnt(8)
    s_bitcmp1_b32 s21, 3
    s_cbranch_scc0 L_SK0
    v_add_lshl_u32 v88, v88, v48, 2
    v_add_lshl_u32 v89, v89, v49, 2
    ds_write2st64_b32 v88, v106, v107 offset0:0 offset1:69
    ds_write2st64_b32 v89, v108, v109 offset0:0 offset1:69
L_SK0:
    s_bitcmp1_b32 s21, 2
    s_cbranch_scc0 L_SK1
    v_add_lshl_u32 v92, v92, v52, 2
    v_add_lshl_u32 v93, v93, v53, 2
    ds_write2st64_b32 v92, v114, v115 offset0:0 offset1:69
    ds_write2st64_b32 v93, v116, v117 offset0:0 offset1:69
L_SK1:
    s_bitcmp1_b32 s21, 1
    s_cbranch_scc0 L_SK2
    v_add_lshl_u32 v96, v96, v56, 2
    v_add_lshl_u32 v97, v97, v57, 2
    ds_write2st64_b32 v96, v122, v123 offset0:0 offset1:69
    ds_write2st64_b32 v97, v124, v125 offset0:0 offset1:69
L_SK2:
    s_bitcmp1_b32 s21, 0
    s_cbranch_scc0 L_SK3
    v_add_lshl_u32 v100, v100, v60, 2
    v_add_lshl_u32 v101, v101, v61, 2
    ds_write2st64_b32 v100, v130, v131 offset0:0 offset1:69
    ds_write2st64_b32 v101, v132, v133 offset0:0 offset1:69
L_SK3:
    s_mov_b64 exec, vcc
    ds_write2st64_b32 v70, v10, v71 offset0:0 offset1:69
    s_mov_b64 exec, -1
    s_cmp_eq_u32 s61, 7
    s_cbranch_scc1 L_PAD7
    s_cmp_eq_u32 s61, 1
    s_cbranch_scc1 L_PLAN2
L_PLAND:
    v_pk_mov_b32 v[86:87], v[10:11], v[10:11]
    v_pk_mov_b32 v[88:89], v[10:11], v[10:11]
    v_pk_mov_b32 v[90:91], v[10:11], v[10:11]
    v_pk_mov_b32 v[92:93], v[10:11], v[10:11]
    v_pk_mov_b32 v[94:95], v[10:11], v[10:11]
    v_pk_mov_b32 v[96:97], v[10:11], v[10:11]
    v_pk_mov_b32 v[98:99], v[10:11], v[10:11]
    v_pk_mov_b32 v[100:101], v[10:11], v[10:11]
    s_waitcnt lgkmcnt(0)
    v_mfma_f32_32x32x16_bf16 v[102:117], v[10:13], v[10:13], 0
    v_mfma_f32_32x32x16_bf16 v[118:133], v[10:13], v[10:13], 0
    s_barrier
    ds_read_b128 v[30:33], v77 offset:18176
    s_mov_b32 s99, 0
    s_waitcnt lgkmcnt(0)
    v_readfirstlane_b32 s96, v31
    v_add_u32 v226, v30, v237
    v_add_u32 v227, v30, v236
    v_mad_u32_u24 v232, v234, v32, v233
    s_sub_u32 s96, s96, 1
    s_cbranch_scc1 L_IDLE
    s_cmp_ge_u32 s61, 4
    s_cbranch_scc1 L_LOPREP
L_LOPREPD:
    ds_read2st64_b32 v[162:163], v226 offset0:0 offset1:69
    ds_read_b128 v[134:137], v227 offset:0
    ds_read_b128 v[138:141], v227 offset:32
    ds_read_b128 v[142:145], v227 offset:64
    ds_read_b128 v[146:149], v227 offset:96
    ds_read_b128 v[2:5], v232 offset:0
    ds_read_b128 v[6:9], v232 offset:512
    v_readfirstlane_b32 s97, v32
    v_readfirstlane_b32 s98, v33
    s_lshl_b32 s100, s97, 11
    s_add_u32 s100, s100, 26880
    s_waitcnt lgkmcnt(6)
    buffer_load_dwordx3 v[164:166], v162, s[32:35], 0 idxen sc1
    v_lshlrev_b32_sdwa v224, 4, v163 dst_sel:DWORD dst_unused:UNUSED_PAD src0_sel:DWORD src1_sel:BYTE_1
    ds_read_b128 v[168:171], v224 offset:14336
    s_waitcnt lgkmcnt(3)
    buffer_load_dword v30, v134, s[28:31], 0 offen sc1
    buffer_load_dword v31, v135, s[28:31], 0 offen sc1
    buffer_load_dword v32, v136, s[28:31], 0 offen sc1
    buffer_load_dword v33, v137, s[28:31], 0 offen sc1
    buffer_load_dword v34, v138, s[28:31], 0 offen sc1
    buffer_load_dword v35, v139, s[28:31], 0 offen sc1
    buffer_load_dword v36, v140, s[28:31], 0 offen sc1
    buffer_load_dword v37, v141, s[28:31], 0 offen sc1
    buffer_load_dword v38, v142, s[28:31], 0 offen sc1
    buffer_load_dword v39, v143, s[28:31], 0 offen sc1
    buffer_load_dword v40, v144, s[28:31], 0 offen sc1
    buffer_load_dword v41, v145, s[28:31], 0 offen sc1
    buffer_load_dword v42, v146, s[28:31], 0 offen sc1
    buffer_load_dword v43, v147, s[28:31], 0 offen sc1
    buffer_load_dword v44, v148, s[28:31], 0 offen sc1
    buffer_load_dword v45, v149, s[28:31], 0 offen sc1
    ds_read_b128 v[134:137], v227 offset:128
    ds_read_b128 v[138:141], v227 offset:160
    ds_read_b128 v[142:145], v227 offset:192
    ds_read_b128 v[146:149], v227 offset:224
    v_add_u32 v226, 256, v226
    s_cmp_lt_u32 s61, 4
    s_cbranch_scc0 L_NOPRIO
    s_setprio 1
L_NOPRIO:
    s_cmp_ge_u32 s61, 4
    s_cbranch_scc1 L_HIPREPD
    v_lshlrev_b32 v75, 1, v1
    ds_read_u16 v75, v75 offset:15296
    v_lshlrev_b32 v70, 3, v1
    ds_read_b64 v[72:73], v70 offset:15232
    s_waitcnt lgkmcnt(0)
    v_lshrrev_b32 v75, 5, v75
    s_mov_b32 m0, s61
    v_readlane_b32 s52, v75, 0
    v_readlane_b32 s53, v75, 1
    v_readlane_b32 s54, v75, 2
    v_readlane_b32 s55, v75, 3
    v_readlane_b32 s56, v75, 4
    v_readlane_b32 s57, v75, 5
    v_readlane_b32 s58, v75, 6
    v_readlane_b32 s59, v75, 7
    s_nop 1
    s_movrels_b32 s19, s52
    s_movrels_b32 s20, s53
    v_cmp_lt_u32 s[72:73], s19, v73
    v_cmp_ge_u32 vcc, s20, v73
    v_cmp_gt_u32 s[74:75], s20, v72
    v_cmp_lt_u32 s[76:77], s20, v73
    s_sub_u32 s65, s20, s19
    s_and_b32 s64, s72, vcc_lo
    s_and_b32 s64, s64, 0xff
    s_and_b32 s3, s74, s76
    s_and_b32 s3, s3, 0xff
    s_cselect_b32 s3, 0x100, 0
    s_or_b32 s64, s64, s3
    s_cmp_eq_u32 s65, 0
    s_cselect_b32 s64, 0, s64
    s_cmp_eq_u32 s61, 7
    s_cselect_b32 s64, 0, s64
    s_lshl_b32 s66, s61, 11
    s_add_u32 s66, s66, 26880
    s_ff1_i32_b32 s3, s64
    s_bitset0_b32 s64, s3
    s_mul_i32 s80, s3, 6144
    s_add_u32 s80, s80, 114688
    s_cmp_eq_u32 s3, 8
    s_cselect_b32 s80, s66, s80
    s_cmp_lt_i32 s3, 0
    s_cselect_b32 s80, 0x30000, s80
    s_ff1_i32_b32 s3, s64
    s_bitset0_b32 s64, s3
    s_mul_i32 s81, s3, 6144
    s_add_u32 s81, s81, 114688
    s_cmp_eq_u32 s3, 8
    s_cselect_b32 s81, s66, s81
    s_cmp_lt_i32 s3, 0
    s_cselect_b32 s81, 0x30000, s81
    s_ff1_i32_b32 s3, s64
    s_bitset0_b32 s64, s3
    s_mul_i32 s82, s3, 6144
    s_add_u32 s82, s82, 114688
    s_cmp_eq_u32 s3, 8
    s_cselect_b32 s82, s66, s82
    s_cmp_lt_i32 s3, 0
    s_cselect_b32 s82, 0x30000, s82
L_HIPREPD:
    s_waitcnt vmcnt(16) lgkmcnt(4)
    v_pk_add_f32 v[168:169], v[168:169], v[164:165] neg_lo:[0,1] neg_hi:[0,1]
    v_sub_f32 v170, v170, v166
    v_mul_f32 v224, v168, v168
    v_cvt_pk_bf16_f32 v172, 1.0, v168
    v_fmac_f32 v224, v169, v169
    v_cvt_pk_bf16_f32 v173, v169, v170
    v_fmac_f32 v224, v170, v170
    v_lshrrev_b32_sdwa v171, 2, v163 dst_sel:DWORD dst_unused:UNUSED_PAD src0_sel:DWORD src1_sel:BYTE_0
    v_cvt_pk_bf16_f32 v223, v224, v163
    v_add_u32_sdwa v164, v230, v163 dst_sel:DWORD dst_unused:UNUSED_PAD src0_sel:DWORD src1_sel:BYTE_0
    v_add_u32 v165, v231, v171
    ds_write_b64 v164, v[172:173]
    ds_write_b16 v165, v222
    ds_write2_b32 v225, v223, v223 offset0:0 offset1:1
    ds_read_b128 v[158:161], v228 offset:0
    v_pk_mov_b32 v[220:221], v[164:165], v[164:165] op_sel:[0,1]
    s_waitcnt vmcnt(0)
    v_lshlrev_b32 v14, 16, v30
    v_lshlrev_b32 v15, 16, v31
    v_lshlrev_b32 v16, 16, v32
    v_lshlrev_b32 v17, 16, v33
    v_lshlrev_b32 v18, 16, v34
    v_lshlrev_b32 v19, 16, v35
    v_lshlrev_b32 v20, 16, v36
    v_lshlrev_b32 v21, 16, v37
    v_lshlrev_b32 v22, 16, v38
    v_lshlrev_b32 v23, 16, v39
    v_lshlrev_b32 v24, 16, v40
    v_lshlrev_b32 v25, 16, v41
    v_lshlrev_b32 v26, 16, v42
    v_lshlrev_b32 v27, 16, v43
    v_lshlrev_b32 v28, 16, v44
    v_lshlrev_b32 v29, 16, v45
    s_waitcnt lgkmcnt(0)
    s_cmp_lg_u32 s48, 0
    v_mfma_f32_32x32x16_bf16 v[14:29], v[158:161], v[2:5], v[14:29]
    v_mfma_f32_32x32x16_bf16 v[30:45], v[158:161], v[6:9], v[30:45]
    s_nop 7
    s_nop 1
    s_cbranch_scc0 L_LOOP
    .p2align 3
L_LOOPL:
    v_mad_u32_u16 v62, v22, 2, s47 op_sel:[1,0,0,0]
    v_mad_u32_u16 v63, v23, 2, s47 op_sel:[1,0,0,0]
    v_mad_u32_u16 v64, v24, 2, s47 op_sel:[1,0,0,0]
    v_mad_u32_u16 v65, v25, 2, s47 op_sel:[1,0,0,0]
    v_mad_u32_u16 v66, v26, 2, s47 op_sel:[1,0,0,0]
    v_mad_u32_u16 v67, v27, 2, s47 op_sel:[1,0,0,0]
    v_mad_u32_u16 v68, v28, 2, s47 op_sel:[1,0,0,0]
    v_mad_u32_u16 v69, v29, 2, s47 op_sel:[1,0,0,0]
    s_waitcnt lgkmcnt(6)
    buffer_load_dword v46, v134, s[28:31], 0 offen sc1
    buffer_load_dword v47, v135, s[28:31], 0 offen sc1
    buffer_load_dword v48, v136, s[28:31], 0 offen sc1
    buffer_load_dword v49, v137, s[28:31], 0 offen sc1
    buffer_load_dword v50, v138, s[28:31], 0 offen sc1
    buffer_load_dword v51, v139, s[28:31], 0 offen sc1
    buffer_load_dword v52, v140, s[28:31], 0 offen sc1
    buffer_load_dword v53, v141, s[28:31], 0 offen sc1
    buffer_load_dword v54, v142, s[28:31], 0 offen sc1
    buffer_load_dword v55, v143, s[28:31], 0 offen sc1
    buffer_load_dword v56, v144, s[28:31], 0 offen sc1
    buffer_load_dword v57, v145, s[28:31], 0 offen sc1
    buffer_load_dword v58, v146, s[28:31], 0 offen sc1
    buffer_load_dword v59, v147, s[28:31], 0 offen sc1
    buffer_load_dword v60, v148, s[28:31], 0 offen sc1
    buffer_load_dword v61, v149, s[28:31], 0 offen sc1
    ds_read_b128 v[134:137], v227 offset:256
    ds_read_b128 v[138:141], v227 offset:288
    ds_read_b128 v[142:145], v227 offset:320
    ds_read_b128 v[146:149], v227 offset:352
    ds_read2st64_b32 v[162:163], v226 offset0:0 offset1:69
    ds_read_u16_d16 v62, v62
    ds_read_u16_d16_hi v63, v63
    ds_read_u16_d16 v64, v64
    ds_read_u16_d16_hi v65, v65
    ds_read_u16_d16 v66, v66
    ds_read_u16_d16_hi v67, v67
    ds_read_u16_d16 v68, v68
    ds_read_u16_d16_hi v69, v69
    v_mfma_f32_32x32x16_bf16 v[102:117], v[86:89], v[150:153], v[102:117]
    v_exp_f32 v70, v14
    v_exp_f32 v71, v15
    v_exp_f32 v72, v16
    v_exp_f32 v73, v17
    v_mfma_f32_32x32x16_bf16 v[102:117], v[90:93], v[154:157], v[102:117]
    v_exp_f32 v74, v18
    v_exp_f32 v75, v19
    v_exp_f32 v76, v20
    v_exp_f32 v77, v21
    v_pk_add_f32 v[70:71], v[70:71], 1.0 op_sel_hi:[1,0]
    v_pk_add_f32 v[72:73], v[72:73], 1.0 op_sel_hi:[1,0]
    v_pk_add_f32 v[74:75], v[74:75], 1.0 op_sel_hi:[1,0]
    v_pk_add_f32 v[76:77], v[76:77], 1.0 op_sel_hi:[1,0]
    s_waitcnt lgkmcnt(13)
    v_or_b32 v99, v80, v81
    v_or_b32 v100, v82, v83
    v_or_b32 v101, v84, v85
    v_mfma_f32_32x32x16_bf16 v[118:133], v[94:97], v[150:153], v[118:133]
    v_rcp_f32 v70, v70
    v_rcp_f32 v71, v71
    v_rcp_f32 v72, v72
    v_rcp_f32 v73, v73
    v_mfma_f32_32x32x16_bf16 v[118:133], v[98:101], v[154:157], v[118:133]
    v_rcp_f32 v74, v74
    v_rcp_f32 v75, v75
    v_rcp_f32 v76, v76
    v_rcp_f32 v77, v77
    v_pk_mul_f32 v[70:71], v[70:71], v[14:15]
    v_pk_mul_f32 v[72:73], v[72:73], v[16:17]
    v_pk_mul_f32 v[74:75], v[74:75], v[18:19]
    v_pk_mul_f32 v[76:77], v[76:77], v[20:21]
    v_cvt_pk_bf16_f32 v86, v70, v71
    v_cvt_pk_bf16_f32 v87, v72, v73
    v_cvt_pk_bf16_f32 v88, v74, v75
    v_cvt_pk_bf16_f32 v89, v76, v77
    s_waitcnt lgkmcnt(8)
    v_lshlrev_b32_sdwa v224, 4, v163 dst_sel:DWORD dst_unused:UNUSED_PAD src0_sel:DWORD src1_sel:BYTE_1
    s_sub_u32 s98, s98, 1
    s_cbranch_scc1 L_EVAL
L_NOADVAL:
    v_mad_u32_u16 v80, v40, 2, s47 op_sel:[1,0,0,0]
    v_mad_u32_u16 v81, v41, 2, s47 op_sel:[1,0,0,0]
    v_mad_u32_u16 v82, v42, 2, s47 op_sel:[1,0,0,0]
    v_mad_u32_u16 v83, v43, 2, s47 op_sel:[1,0,0,0]
    v_mad_u32_u16 v84, v44, 2, s47 op_sel:[1,0,0,0]
    v_mad_u32_u16 v85, v45, 2, s47 op_sel:[1,0,0,0]
    buffer_load_dwordx3 v[164:166], v162, s[32:35], 0 idxen sc1
    ds_read_b128 v[168:171], v224 offset:14336
    ds_read_b128 v[158:161], v228 offset:512
    ds_read_b64_tr_b16 v[150:151], v229 offset:0
    ds_read_b64_tr_b16 v[152:153], v229 offset:512
    ds_read_b64_tr_b16 v[154:155], v229 offset:1024
    ds_read_b64_tr_b16 v[156:157], v229 offset:1536
    ds_read_u16_d16 v80, v80
    ds_read_u16_d16_hi v81, v81
    ds_read_u16_d16 v82, v82
    ds_read_u16_d16_hi v83, v83
    ds_read_u16_d16 v84, v84
    ds_read_u16_d16_hi v85, v85
    v_exp_f32 v70, v30
    v_exp_f32 v71, v31
    v_exp_f32 v72, v32
    v_exp_f32 v73, v33
    v_exp_f32 v74, v34
    v_exp_f32 v75, v35
    v_exp_f32 v76, v36
    v_exp_f32 v77, v37
    v_exp_f32 v78, v38
    v_exp_f32 v79, v39
    v_pk_add_f32 v[70:71], v[70:71], 1.0 op_sel_hi:[1,0]
    v_pk_add_f32 v[72:73], v[72:73], 1.0 op_sel_hi:[1,0]
    v_pk_add_f32 v[74:75], v[74:75], 1.0 op_sel_hi:[1,0]
    v_pk_add_f32 v[76:77], v[76:77], 1.0 op_sel_hi:[1,0]
    v_pk_add_f32 v[78:79], v[78:79], 1.0 op_sel_hi:[1,0]
    s_waitcnt vmcnt(1) lgkmcnt(10)
    v_lshlrev_b32 v14, 16, v46
    v_lshlrev_b32 v15, 16, v47
    v_lshlrev_b32 v16, 16, v48
    v_lshlrev_b32 v17, 16, v49
    v_lshlrev_b32 v18, 16, v50
    v_lshlrev_b32 v19, 16, v51
    v_lshlrev_b32 v20, 16, v52
    v_lshlrev_b32 v21, 16, v53
    v_lshlrev_b32 v22, 16, v54
    v_lshlrev_b32 v23, 16, v55
    v_lshlrev_b32 v24, 16, v56
    v_lshlrev_b32 v25, 16, v57
    v_lshlrev_b32 v26, 16, v58
    v_lshlrev_b32 v27, 16, v59
    v_lshlrev_b32 v28, 16, v60
    v_lshlrev_b32 v29, 16, v61
    v_or_b32 v90, v62, v63
    v_or_b32 v91, v64, v65
    v_or_b32 v92, v66, v67
    v_or_b32 v93, v68, v69
    v_mfma_f32_32x32x16_bf16 v[14:29], v[158:161], v[2:5], v[14:29]
    v_rcp_f32 v70, v70
    v_rcp_f32 v71, v71
    v_rcp_f32 v72, v72
    v_rcp_f32 v73, v73
    v_mfma_f32_32x32x16_bf16 v[46:61], v[158:161], v[6:9], v[46:61]
    v_rcp_f32 v74, v74
    v_rcp_f32 v75, v75
    v_rcp_f32 v76, v76
    v_rcp_f32 v77, v77
    v_rcp_f32 v78, v78
    v_rcp_f32 v79, v79
    v_pk_mul_f32 v[70:71], v[70:71], v[30:31]
    v_pk_mul_f32 v[72:73], v[72:73], v[32:33]
    v_pk_mul_f32 v[74:75], v[74:75], v[34:35]
    v_pk_mul_f32 v[76:77], v[76:77], v[36:37]
    v_pk_mul_f32 v[78:79], v[78:79], v[38:39]
    v_cvt_pk_bf16_f32 v94, v70, v71
    v_cvt_pk_bf16_f32 v95, v72, v73
    v_cvt_pk_bf16_f32 v96, v74, v75
    v_cvt_pk_bf16_f32 v97, v76, v77
    v_cvt_pk_bf16_f32 v98, v78, v79
    s_sub_u32 s96, s96, 1
    s_cbranch_scc1 L_DRAINL
    v_mad_u32_u16 v62, v22, 2, s47 op_sel:[1,0,0,0]
    v_mad_u32_u16 v63, v23, 2, s47 op_sel:[1,0,0,0]
    v_mad_u32_u16 v64, v24, 2, s47 op_sel:[1,0,0,0]
    v_mad_u32_u16 v65, v25, 2, s47 op_sel:[1,0,0,0]
    v_mad_u32_u16 v66, v26, 2, s47 op_sel:[1,0,0,0]
    v_mad_u32_u16 v67, v27, 2, s47 op_sel:[1,0,0,0]
    v_mad_u32_u16 v68, v28, 2, s47 op_sel:[1,0,0,0]
    v_mad_u32_u16 v69, v29, 2, s47 op_sel:[1,0,0,0]
    s_waitcnt lgkmcnt(6)
    buffer_load_dword v30, v134, s[28:31], 0 offen sc1
    buffer_load_dword v31, v135, s[28:31], 0 offen sc1
    buffer_load_dword v32, v136, s[28:31], 0 offen sc1
    buffer_load_dword v33, v137, s[28:31], 0 offen sc1
    buffer_load_dword v34, v138, s[28:31], 0 offen sc1
    buffer_load_dword v35, v139, s[28:31], 0 offen sc1
    buffer_load_dword v36, v140, s[28:31], 0 offen sc1
    buffer_load_dword v37, v141, s[28:31], 0 offen sc1
    buffer_load_dword v38, v142, s[28:31], 0 offen sc1
    buffer_load_dword v39, v143, s[28:31], 0 offen sc1
    buffer_load_dword v40, v144, s[28:31], 0 offen sc1
    buffer_load_dword v41, v145, s[28:31], 0 offen sc1
    buffer_load_dword v42, v146, s[28:31], 0 offen sc1
    buffer_load_dword v43, v147, s[28:31], 0 offen sc1
    buffer_load_dword v44, v148, s[28:31], 0 offen sc1
    buffer_load_dword v45, v149, s[28:31], 0 offen sc1
    ds_read_b128 v[134:137], v227 offset:384
    ds_read_b128 v[138:141], v227 offset:416
    ds_read_b128 v[142:145], v227 offset:448
    ds_read_b128 v[146:149], v227 offset:480
    ds_read_u16_d16 v62, v62
    ds_read_u16_d16_hi v63, v63
    ds_read_u16_d16 v64, v64
    ds_read_u16_d16_hi v65, v65
    ds_read_u16_d16 v66, v66
    ds_read_u16_d16_hi v67, v67
    ds_read_u16_d16 v68, v68
    ds_read_u16_d16_hi v69, v69
    v_mfma_f32_32x32x16_bf16 v[102:117], v[86:89], v[150:153], v[102:117]
    v_exp_f32 v70, v14
    v_exp_f32 v71, v15
    v_exp_f32 v72, v16
    v_exp_f32 v73, v17
    v_mfma_f32_32x32x16_bf16 v[102:117], v[90:93], v[154:157], v[102:117]
    v_exp_f32 v74, v18
    v_exp_f32 v75, v19
    v_exp_f32 v76, v20
    v_exp_f32 v77, v21
    v_pk_add_f32 v[70:71], v[70:71], 1.0 op_sel_hi:[1,0]
    v_pk_add_f32 v[72:73], v[72:73], 1.0 op_sel_hi:[1,0]
    v_pk_add_f32 v[74:75], v[74:75], 1.0 op_sel_hi:[1,0]
    v_pk_add_f32 v[76:77], v[76:77], 1.0 op_sel_hi:[1,0]
    s_waitcnt lgkmcnt(12)
    v_or_b32 v99, v80, v81
    v_or_b32 v100, v82, v83
    v_or_b32 v101, v84, v85
    v_mfma_f32_32x32x16_bf16 v[118:133], v[94:97], v[150:153], v[118:133]
    v_rcp_f32 v70, v70
    v_rcp_f32 v71, v71
    v_rcp_f32 v72, v72
    v_rcp_f32 v73, v73
    v_mfma_f32_32x32x16_bf16 v[118:133], v[98:101], v[154:157], v[118:133]
    v_rcp_f32 v74, v74
    v_rcp_f32 v75, v75
    v_rcp_f32 v76, v76
    v_rcp_f32 v77, v77
    v_pk_mul_f32 v[70:71], v[70:71], v[14:15]
    v_pk_mul_f32 v[72:73], v[72:73], v[16:17]
    v_pk_mul_f32 v[74:75], v[74:75], v[18:19]
    v_pk_mul_f32 v[76:77], v[76:77], v[20:21]
    v_cvt_pk_bf16_f32 v86, v70, v71
    v_cvt_pk_bf16_f32 v87, v72, v73
    v_cvt_pk_bf16_f32 v88, v74, v75
    v_cvt_pk_bf16_f32 v89, v76, v77
    s_waitcnt vmcnt(16)
    v_pk_add_f32 v[168:169], v[168:169], v[164:165] neg_lo:[0,1] neg_hi:[0,1]
    v_sub_f32 v170, v170, v166
    v_mul_f32 v224, v168, v168
    v_cvt_pk_bf16_f32 v172, 1.0, v168
    v_fmac_f32 v224, v169, v169
    v_cvt_pk_bf16_f32 v173, v169, v170
    v_fmac_f32 v224, v170, v170
    v_lshrrev_b32_sdwa v171, 2, v163 dst_sel:DWORD dst_unused:UNUSED_PAD src0_sel:DWORD src1_sel:BYTE_0
    v_cvt_pk_bf16_f32 v223, v224, v163
    v_add_u32_sdwa v164, v230, v163 dst_sel:DWORD dst_unused:UNUSED_PAD src0_sel:DWORD src1_sel:BYTE_0
    v_add_u32 v165, v231, v171
    v_add_u32 v226, 256, v226
    v_add_u32 v227, 256, v227
    s_sub_u32 s98, s98, 1
    s_cbranch_scc1 L_EVBL
L_NOADVBL:
    v_mad_u32_u16 v80, v56, 2, s47 op_sel:[1,0,0,0]
    v_mad_u32_u16 v81, v57, 2, s47 op_sel:[1,0,0,0]
    v_mad_u32_u16 v82, v58, 2, s47 op_sel:[1,0,0,0]
    v_mad_u32_u16 v83, v59, 2, s47 op_sel:[1,0,0,0]
    v_mad_u32_u16 v84, v60, 2, s47 op_sel:[1,0,0,0]
    v_mad_u32_u16 v85, v61, 2, s47 op_sel:[1,0,0,0]
    ds_read_b64_tr_b16 v[150:151], v229 offset:2048
    ds_read_b64_tr_b16 v[152:153], v229 offset:2560
    ds_read_b64_tr_b16 v[154:155], v229 offset:3072
    ds_read_b64_tr_b16 v[156:157], v229 offset:3584
    ds_write_b64 v220, v[10:11]
    ds_write_b16 v221, v10
    ds_write_b64 v164, v[172:173]
    ds_write_b16 v165, v222
    ds_write2_b32 v225, v223, v223 offset0:0 offset1:1
    ds_read_b128 v[158:161], v228 offset:0
    ds_read_u16_d16 v80, v80
    ds_read_u16_d16_hi v81, v81
    ds_read_u16_d16 v82, v82
    ds_read_u16_d16_hi v83, v83
    ds_read_u16_d16 v84, v84
    ds_read_u16_d16_hi v85, v85
    v_exp_f32 v70, v46
    v_exp_f32 v71, v47
    v_exp_f32 v72, v48
    v_exp_f32 v73, v49
    v_exp_f32 v74, v50
    v_exp_f32 v75, v51
    v_exp_f32 v76, v52
    v_exp_f32 v77, v53
    v_exp_f32 v78, v54
    v_exp_f32 v79, v55
    v_pk_add_f32 v[70:71], v[70:71], 1.0 op_sel_hi:[1,0]
    v_pk_add_f32 v[72:73], v[72:73], 1.0 op_sel_hi:[1,0]
    v_pk_add_f32 v[74:75], v[74:75], 1.0 op_sel_hi:[1,0]
    v_pk_add_f32 v[76:77], v[76:77], 1.0 op_sel_hi:[1,0]
    v_pk_add_f32 v[78:79], v[78:79], 1.0 op_sel_hi:[1,0]
    v_pk_mov_b32 v[220:221], v[164:165], v[164:165] op_sel:[0,1]
    s_waitcnt vmcnt(0) lgkmcnt(6)
    v_lshlrev_b32 v14, 16, v30
    v_lshlrev_b32 v15, 16, v31
    v_lshlrev_b32 v16, 16, v32
    v_lshlrev_b32 v17, 16, v33
    v_lshlrev_b32 v18, 16, v34
    v_lshlrev_b32 v19, 16, v35
    v_lshlrev_b32 v20, 16, v36
    v_lshlrev_b32 v21, 16, v37
    v_lshlrev_b32 v22, 16, v38
    v_lshlrev_b32 v23, 16, v39
    v_lshlrev_b32 v24, 16, v40
    v_lshlrev_b32 v25, 16, v41
    v_lshlrev_b32 v26, 16, v42
    v_lshlrev_b32 v27, 16, v43
    v_lshlrev_b32 v28, 16, v44
    v_lshlrev_b32 v29, 16, v45
    v_or_b32 v90, v62, v63
    v_or_b32 v91, v64, v65
    v_or_b32 v92, v66, v67
    v_or_b32 v93, v68, v69
    v_mfma_f32_32x32x16_bf16 v[14:29], v[158:161], v[2:5], v[14:29]
    v_rcp_f32 v70, v70
    v_rcp_f32 v71, v71
    v_rcp_f32 v72, v72
    v_rcp_f32 v73, v73
    v_mfma_f32_32x32x16_bf16 v[30:45], v[158:161], v[6:9], v[30:45]
    v_rcp_f32 v74, v74
    v_rcp_f32 v75, v75
    v_rcp_f32 v76, v76
    v_rcp_f32 v77, v77
    v_rcp_f32 v78, v78
    v_rcp_f32 v79, v79
    v_pk_mul_f32 v[70:71], v[70:71], v[46:47]
    v_pk_mul_f32 v[72:73], v[72:73], v[48:49]
    v_pk_mul_f32 v[74:75], v[74:75], v[50:51]
    v_pk_mul_f32 v[76:77], v[76:77], v[52:53]
    v_pk_mul_f32 v[78:79], v[78:79], v[54:55]
    v_cvt_pk_bf16_f32 v94, v70, v71
    v_cvt_pk_bf16_f32 v95, v72, v73
    v_cvt_pk_bf16_f32 v96, v74, v75
    v_cvt_pk_bf16_f32 v97, v76, v77
    v_cvt_pk_bf16_f32 v98, v78, v79
    s_sub_u32 s96, s96, 1
    s_cbranch_scc0 L_LOOPL
L_DRAINL:
    s_waitcnt lgkmcnt(0)
    v_or_b32 v99, v80, v81
    v_or_b32 v100, v82, v83
    v_or_b32 v101, v84, v85
L_DRAIN:
    s_waitcnt lgkmcnt(0)
    s_mul_i32 s100, s61, 6144
    s_add_u32 s100, s100, 114688
    v_mfma_f32_32x32x16_bf16 v[102:117], v[86:89], v[150:153], v[102:117]
    v_mfma_f32_32x32x16_bf16 v[118:133], v[94:97], v[150:153], v[118:133]
    v_mfma_f32_32x32x16_bf16 v[102:117], v[90:93], v[154:157], v[102:117]
    v_mfma_f32_32x32x16_bf16 v[118:133], v[98:101], v[154:157], v[118:133]
    ds_read_b128 v[70:73], v236 offset:18432
    ds_read_b128 v[74:77], v236 offset:18464
    ds_read_b128 v[78:81], v236 offset:18496
    ds_read_b128 v[82:85], v236 offset:18528
    ds_read_b128 v[14:17], v236 offset:18560
    ds_read_b128 v[18:21], v236 offset:18592
    ds_read_b128 v[22:25], v236 offset:18624
    ds_read_b128 v[26:29], v236 offset:18656
    s_nop 7
    v_add_u32 v174, s100, v235
    v_add_u32 v175, s100, v237
    s_mov_b64 exec, s[22:23]
    ds_write_b128 v174, v[102:105] offset:0
    ds_write_b128 v174, v[106:109] offset:32
    ds_write_b128 v174, v[110:113] offset:64
    ds_write_b128 v174, v[114:117] offset:96
    ds_write_b128 v174, v[118:121] offset:128
    ds_write_b128 v174, v[122:125] offset:160
    ds_write_b128 v174, v[126:129] offset:192
    ds_write_b128 v174, v[130:133] offset:224
    s_mov_b64 exec, -1
    s_waitcnt lgkmcnt(8)
    v_pk_mul_f32 v[70:71], v[70:71], v[102:103]
    v_pk_mul_f32 v[72:73], v[72:73], v[104:105]
    v_pk_mul_f32 v[74:75], v[74:75], v[106:107]
    v_pk_mul_f32 v[76:77], v[76:77], v[108:109]
    v_pk_mul_f32 v[78:79], v[78:79], v[110:111]
    v_pk_mul_f32 v[80:81], v[80:81], v[112:113]
    v_pk_mul_f32 v[82:83], v[82:83], v[114:115]
    v_pk_mul_f32 v[84:85], v[84:85], v[116:117]
    v_pk_fma_f32 v[70:71], v[14:15], v[118:119], v[70:71]
    v_pk_fma_f32 v[72:73], v[16:17], v[120:121], v[72:73]
    v_pk_fma_f32 v[74:75], v[18:19], v[122:123], v[74:75]
    v_pk_fma_f32 v[76:77], v[20:21], v[124:125], v[76:77]
    v_pk_fma_f32 v[78:79], v[22:23], v[126:127], v[78:79]
    v_pk_fma_f32 v[80:81], v[24:25], v[128:129], v[80:81]
    v_pk_fma_f32 v[82:83], v[26:27], v[130:131], v[82:83]
    v_pk_fma_f32 v[84:85], v[28:29], v[132:133], v[84:85]
    v_pk_add_f32 v[70:71], v[70:71], v[78:79]
    v_pk_add_f32 v[72:73], v[72:73], v[80:81]
    v_pk_add_f32 v[74:75], v[74:75], v[82:83]
    v_pk_add_f32 v[76:77], v[76:77], v[84:85]
    v_pk_add_f32 v[70:71], v[70:71], v[74:75]
    v_pk_add_f32 v[72:73], v[72:73], v[76:77]
    v_pk_add_f32 v[70:71], v[70:71], v[72:73]
    v_add_f32 v70, v70, v71
    ds_write_b32 v175, v70 offset:1792
L_DONE:
    s_waitcnt vmcnt(0)
    v_add_u32 v168, s80, v247
    v_add_u32 v169, s80, v248
    v_add_u32 v170, s81, v247
    v_add_u32 v171, s81, v248
    v_add_u32 v164, s82, v247
    v_add_u32 v165, s82, v248
    s_mov_b32 s48, 0xbf317218
    s_mov_b32 s49, s48
    s_waitcnt lgkmcnt(0)
    s_barrier
    ds_read_b128 v[70:73], v168
    ds_read_b128 v[74:77], v168 offset:16
    ds_read_b32 v78, v169 offset:1792
    ds_read_b32 v79, v169 offset:1920
    ds_read_b128 v[14:17], v170
    ds_read_b128 v[18:21], v170 offset:16
    ds_read_b32 v22, v171 offset:1792
    ds_read_b32 v23, v171 offset:1920
    ds_read_b128 v[30:33], v164
    ds_read_b128 v[34:37], v164 offset:16
    ds_read_b32 v38, v165 offset:1792
    ds_read_b32 v39, v165 offset:1920
    v_lshlrev_b32 v46, 16, v216
    v_and_b32 v47, 0xffff0000, v216
    v_lshlrev_b32 v48, 16, v217
    v_and_b32 v49, 0xffff0000, v217
    v_lshlrev_b32 v50, 16, v218
    v_and_b32 v51, 0xffff0000, v218
    v_lshlrev_b32 v52, 16, v219
    v_and_b32 v53, 0xffff0000, v219
    s_waitcnt lgkmcnt(8)
    v_pk_add_f32 v[176:177], v[176:177], v[70:71]
    v_pk_add_f32 v[178:179], v[178:179], v[72:73]
    v_pk_add_f32 v[180:181], v[180:181], v[74:75]
    v_pk_add_f32 v[182:183], v[182:183], v[76:77]
    v_add_f32 v238, v238, v78
    v_add_f32 v238, v238, v79
    s_waitcnt lgkmcnt(4)
    v_pk_add_f32 v[176:177], v[176:177], v[14:15]
    v_pk_add_f32 v[178:179], v[178:179], v[16:17]
    v_pk_add_f32 v[180:181], v[180:181], v[18:19]
    v_pk_add_f32 v[182:183], v[182:183], v[20:21]
    v_add_f32 v238, v238, v22
    v_add_f32 v238, v238, v23
    s_or_b32 s3, s64, s63
    s_waitcnt lgkmcnt(0)
    v_pk_add_f32 v[176:177], v[176:177], v[30:31]
    v_pk_add_f32 v[178:179], v[178:179], v[32:33]
    v_pk_add_f32 v[180:181], v[180:181], v[34:35]
    v_pk_add_f32 v[182:183], v[182:183], v[36:37]
    v_add_f32 v238, v238, v38
    v_add_f32 v238, v238, v39
    s_cbranch_scc1 L_COMB
L_FINAL:
    v_pk_mul_f32 v[176:177], v[176:177], s[48:49]
    v_pk_mul_f32 v[178:179], v[178:179], s[48:49]
    v_pk_mul_f32 v[180:181], v[180:181], s[48:49]
    v_pk_mul_f32 v[182:183], v[182:183], s[48:49]
    v_cvt_pk_bf16_f32 v70, v176, v177
    v_cvt_pk_bf16_f32 v71, v178, v179
    v_cvt_pk_bf16_f32 v72, v180, v181
    v_cvt_pk_bf16_f32 v73, v182, v183
    ds_write_b128 v249, v[70:73]
    v_fmac_f32 v251, s48, v238
    s_mov_b32 s48, 0xbfb8aa3b
    s_mov_b32 s49, s48
    v_cvt_pk_bf16_f32 v251, v251, v251
    s_waitcnt lgkmcnt(0)
    s_barrier
    ds_read_b128 v[30:33], v250 offset:0
    ds_read_b128 v[34:37], v250 offset:32
    ds_read_b128 v[38:41], v250 offset:64
    ds_read_b128 v[42:45], v250 offset:96
    s_mov_b32 exec_lo, s13
    s_mov_b32 exec_hi, 0
    buffer_store_short v251, v252, s[40:43], s12 offen
    s_mov_b64 exec, -1
    s_waitcnt lgkmcnt(3)
    v_mfma_f32_32x32x16_bf16 v[200:215], v[184:187], v[30:33], v[200:215]
    s_waitcnt lgkmcnt(2)
    v_mfma_f32_32x32x16_bf16 v[200:215], v[188:191], v[34:37], v[200:215]
    s_waitcnt lgkmcnt(1)
    v_mfma_f32_32x32x16_bf16 v[200:215], v[192:195], v[38:41], v[200:215]
    s_waitcnt lgkmcnt(0)
    v_mfma_f32_32x32x16_bf16 v[200:215], v[196:199], v[42:45], v[200:215]
    s_sub_u32 s3, 12500, s18
    v_lshrrev_b32 v168, 7, v246
    v_cmp_gt_i32 s[70:71], s3, v168
    s_mov_b32 s3, 0x7f7f7f7f
    s_bitcmp1_b32 s61, 1
    s_cselect_b32 s3, 0x007f7f7f, s3
    s_and_b32 s70, s70, s3
    s_and_b32 s71, s71, s3
    s_nop 1
    s_cmp_ge_u32 s61, 4
    s_cbranch_scc0 L_Q0
    v_pk_mov_b32 v[200:201], v[208:209], v[208:209] op_sel:[0,1]
    v_pk_mov_b32 v[202:203], v[210:211], v[210:211] op_sel:[0,1]
    v_pk_mov_b32 v[204:205], v[212:213], v[212:213] op_sel:[0,1]
    v_pk_mov_b32 v[206:207], v[214:215], v[214:215] op_sel:[0,1]
L_Q0:
    v_pk_mul_f32 v[70:71], v[200:201], s[48:49]
    v_pk_mul_f32 v[72:73], v[202:203], s[48:49]
    v_pk_mul_f32 v[74:75], v[204:205], s[48:49]
    v_pk_mul_f32 v[76:77], v[206:207], s[48:49]
    v_exp_f32 v70, v70
    v_exp_f32 v71, v71
    v_exp_f32 v72, v72
    v_exp_f32 v73, v73
    v_exp_f32 v74, v74
    v_exp_f32 v75, v75
    v_exp_f32 v76, v76
    v_exp_f32 v77, v77
    v_pk_add_f32 v[70:71], v[70:71], 1.0 op_sel_hi:[1,0]
    v_pk_add_f32 v[72:73], v[72:73], 1.0 op_sel_hi:[1,0]
    v_pk_add_f32 v[74:75], v[74:75], 1.0 op_sel_hi:[1,0]
    v_pk_add_f32 v[76:77], v[76:77], 1.0 op_sel_hi:[1,0]
    v_rcp_f32 v70, v70
    v_rcp_f32 v71, v71
    v_rcp_f32 v72, v72
    v_rcp_f32 v73, v73
    v_rcp_f32 v74, v74
    v_rcp_f32 v75, v75
    v_rcp_f32 v76, v76
    v_rcp_f32 v77, v77
    v_pk_fma_f32 v[70:71], v[70:71], v[200:201], v[46:47]
    v_pk_fma_f32 v[72:73], v[72:73], v[202:203], v[48:49]
    v_pk_fma_f32 v[74:75], v[74:75], v[204:205], v[50:51]
    v_pk_fma_f32 v[76:77], v[76:77], v[206:207], v[52:53]
    v_cvt_pk_bf16_f32 v46, v70, v71
    v_cvt_pk_bf16_f32 v47, v72, v73
    v_cvt_pk_bf16_f32 v48, v74, v75
    v_cvt_pk_bf16_f32 v49, v76, v77
    s_mov_b64 exec, s[70:71]
    buffer_store_dwordx2 v[46:47], v246, s[40:43], s26 offen offset:0
    buffer_store_dwordx2 v[48:49], v246, s[40:43], s26 offen offset:16
L_END:
    s_endpgm
L_W6LD:
    s_mov_b32 s72, s16
    s_mov_b32 s73, s17
    s_mov_b32 s74, 128
    s_mov_b32 s75, 0x20000
    v_lshlrev_b32 v158, 1, v1
    s_mov_b32 s68, 16384
    buffer_load_ushort v34, v158, s[80:83], s68 offen
    buffer_load_ushort v35, v158, s[80:83], s68 offen offset:128
    buffer_load_ushort v36, v158, s[72:75], 0 offen
    s_branch L_W6E
L_W7A:
    s_mov_b32 s64, s6
    s_mov_b32 s65, s7
    s_mov_b32 s66, 75000
    s_mov_b32 s67, 0x20000
    v_add_u32 v159, s101, v1
    v_mul_u32_u24 v158, 6, v159
    buffer_load_ushort v34, v158, s[64:67], 0 offen
    buffer_load_ushort v35, v158, s[64:67], 0 offen offset:2
    buffer_load_ushort v36, v158, s[64:67], 0 offen offset:4
    s_waitcnt vmcnt(3)
    s_barrier
    v_add_u32 v159, s101, v1
    v_lshlrev_b32 v159, 4, v159
    v_mul_u32_u24 v158, 37, v1
    v_lshrrev_b32 v158, 8, v158
    v_add_lshl_u32 v158, v158, v1, 4
    s_waitcnt vmcnt(0)
    v_lshlrev_b32 v34, 16, v34
    v_lshlrev_b32 v35, 16, v35
    v_lshlrev_b32 v36, 16, v36
    v_mov_b32 v37, 0
    v_mul_f32 v175, v34, v34
    v_fmac_f32 v175, v35, v35
    v_fmac_f32 v175, v36, v36
    s_mov_b32 s3, 1638400
    global_load_dwordx2 v[172:173], v10, s[24:25] sc1
    s_mov_b32 exec_hi, 0x1ffff
    buffer_store_dwordx4 v[34:37], v159, s[36:39], s3 offen sc1
    ds_write_b128 v158, v[34:37] offset:14336
    ds_max_u32 v245, v175 offset:2304
    s_mov_b32 exec_hi, -1
    s_barrier
    ds_read_b128 v[86:89], v152 offset:0
    s_add_u32 m0, s98, 95744
    s_add_u32 s21, s98, 8192
    buffer_load_dwordx4 v152, s[80:83], s98 offen lds
    s_add_u32 m0, s98, 79360
    s_nop 0
    buffer_load_dwordx4 v152, s[92:95], s98 offen lds
    s_add_u32 m0, s98, 87552
    s_nop 0
    buffer_load_dwordx4 v152, s[92:95], s21 offen lds
    s_branch L_W6D
L_NONCER:
    s_add_u32 s63, s63, 1
    s_cmp_gt_u32 s63, 100000
    s_cbranch_scc1 L_ABORT
    global_load_dwordx2 v[172:173], v10, s[24:25] sc1
    s_waitcnt vmcnt(0)
    s_branch L_NONCE
L_HDR:
    v_lshlrev_b32 v134, 3, v94
    v_lshlrev_b32 v135, 3, v95
    v_lshlrev_b32 v138, 3, v96
    v_lshlrev_b32 v139, 3, v97
    v_lshl_or_b32 v134, v86, 16, v134
    v_lshl_or_b32 v135, v87, 16, v135
    v_lshl_or_b32 v138, v88, 16, v138
    v_lshl_or_b32 v139, v89, 16, v139
    v_mov_b32 v136, s24
    v_mov_b32 v137, s25
    v_mov_b32 v140, s24
    v_mov_b32 v141, s25
    v_lshlrev_b32 v174, 5, v1
    s_lshl_b32 s3, s2, 11
    s_add_u32 s3, s3, 1900544
    buffer_store_dwordx4 v[134:137], v174, s[36:39], s3 offen sc1
    buffer_store_dwordx4 v[138:141], v174, s[36:39], s3 offen offset:16 sc1
    s_branch L_JOIN
L_FLAG:
    ds_read_b32 v14, v237 offset:17408
    ds_read_b32 v15, v245 offset:2304
    v_lshlrev_b32 v174, 12, v1
    s_lshl_b32 s3, s2, 4
    s_add_u32 s3, s3, 2424832
    s_waitcnt lgkmcnt(0)
    s_nop 1
    v_max_u32_dpp v14, v14, v14 row_shr:1 row_mask:0xf bank_mask:0xf bound_ctrl:0
    v_max_u32_dpp v15, v15, v15 row_shr:1 row_mask:0xf bank_mask:0xf bound_ctrl:0
    s_nop 0
    v_max_u32_dpp v14, v14, v14 row_shr:2 row_mask:0xf bank_mask:0xf bound_ctrl:0
    v_max_u32_dpp v15, v15, v15 row_shr:2 row_mask:0xf bank_mask:0xf bound_ctrl:0
    s_nop 0
    v_max_u32_dpp v14, v14, v14 row_shr:4 row_mask:0xf bank_mask:0xf bound_ctrl:0
    v_max_u32_dpp v15, v15, v15 row_shr:4 row_mask:0xf bank_mask:0xf bound_ctrl:0
    s_nop 0
    v_max_u32_dpp v14, v14, v14 row_shr:8 row_mask:0xf bank_mask:0xf bound_ctrl:0
    v_max_u32_dpp v15, v15, v15 row_shr:8 row_mask:0xf bank_mask:0xf bound_ctrl:0
    s_nop 0
    v_max_u32_dpp v14, v14, v14 row_bcast:15 row_mask:0xa bank_mask:0xf
    v_max_u32_dpp v15, v15, v15 row_bcast:15 row_mask:0xa bank_mask:0xf
    s_nop 1
    v_readlane_b32 s64, v14, 31
    v_readlane_b32 s65, v14, 63
    v_readlane_b32 s66, v15, 31
    v_mov_b32 v18, s24
    v_mov_b32 v19, s25
    s_lshr_b32 s65, s65, 16
    s_add_u32 s66, s66, 0x10000
    s_and_b32 s66, s66, 0xffff0000
    s_or_b32 s65, s65, s66
    v_mov_b32 v20, s64
    v_mov_b32 v21, s65
    s_mov_b64 exec, 0xff
    buffer_store_dwordx4 v[18:21], v174, s[36:39], s3 offen sc1
    s_mov_b64 exec, -1
    s_branch L_NOFLAG
L_FLD:
    s_and_b32 s48, s2, 7
    s_lshl_b32 s48, s48, 12
    s_add_u32 s48, s48, 2424832
    v_lshlrev_b32 v224, 4, v1
    buffer_load_dwordx4 v[14:17], v224, s[36:39], s48 offen offset:0 sc1
    buffer_load_dwordx4 v[18:21], v224, s[36:39], s48 offen offset:1024 sc1
    buffer_load_dwordx4 v[22:25], v224, s[36:39], s48 offen offset:2048 sc1
    buffer_load_dwordx4 v[26:29], v224, s[36:39], s48 offen offset:3072 sc1
    s_branch L_FLDD
L_GUARD:
    s_mov_b32 s3, 0
    s_waitcnt vmcnt(8)
L_FLAGS:
    v_cmp_ne_u64 s[4:5], s[24:25], v[14:15]
    v_cmp_ne_u64 s[6:7], s[24:25], v[18:19]
    v_cmp_ne_u64 s[8:9], s[24:25], v[22:23]
    v_cmp_ne_u64 s[10:11], s[24:25], v[26:27]
    v_max3_u32 v30, v16, v20, v24
    v_max_u32 v30, v30, v28
    v_pk_max_u16 v31, v17, v21
    v_pk_max_u16 v32, v25, v29
    s_or_b64 s[4:5], s[4:5], s[6:7]
    s_or_b64 s[8:9], s[8:9], s[10:11]
    s_or_b64 s[4:5], s[4:5], s[8:9]
    s_cbranch_scc0 L_FLAGOK
    s_add_u32 s3, s3, 1
    s_cmp_gt_u32 s3, 100000
    s_cbranch_scc1 L_ABORT
    s_and_b32 s48, s2, 7
    s_lshl_b32 s48, s48, 12
    s_add_u32 s48, s48, 2424832
    v_lshlrev_b32 v224, 4, v1
    buffer_load_dwordx4 v[14:17], v224, s[36:39], s48 offen offset:0 sc1
    buffer_load_dwordx4 v[18:21], v224, s[36:39], s48 offen offset:1024 sc1
    buffer_load_dwordx4 v[22:25], v224, s[36:39], s48 offen offset:2048 sc1
    buffer_load_dwordx4 v[26:29], v224, s[36:39], s48 offen offset:3072 sc1
    s_waitcnt vmcnt(0)
    s_branch L_FLAGS
L_FLAGOK:
    v_pk_max_u16 v31, v31, v32
    ds_read_b32 v33, v245 offset:2432
    ds_read_b32 v34, v245 offset:2560
    ds_read_b32 v35, v245 offset:2688
    v_lshlrev_b32 v32, 16, v31
    v_and_b32 v31, 0xffff0000, v31
    s_waitcnt lgkmcnt(0)
    s_nop 1
    v_max_u32_dpp v30, v30, v30 row_shr:1 row_mask:0xf bank_mask:0xf bound_ctrl:0
    v_max_u32_dpp v31, v31, v31 row_shr:1 row_mask:0xf bank_mask:0xf bound_ctrl:0
    v_max_u32_dpp v32, v32, v32 row_shr:1 row_mask:0xf bank_mask:0xf bound_ctrl:0
    v_max_u32_dpp v33, v33, v33 row_shr:1 row_mask:0xf bank_mask:0xf bound_ctrl:0
    v_max_u32_dpp v34, v34, v34 row_shr:1 row_mask:0xf bank_mask:0xf bound_ctrl:0
    v_max_u32_dpp v35, v35, v35 row_shr:1 row_mask:0xf bank_mask:0xf bound_ctrl:0
    v_max_u32_dpp v30, v30, v30 row_shr:2 row_mask:0xf bank_mask:0xf bound_ctrl:0
    v_max_u32_dpp v31, v31, v31 row_shr:2 row_mask:0xf bank_mask:0xf bound_ctrl:0
    v_max_u32_dpp v32, v32, v32 row_shr:2 row_mask:0xf bank_mask:0xf bound_ctrl:0
    v_max_u32_dpp v33, v33, v33 row_shr:2 row_mask:0xf bank_mask:0xf bound_ctrl:0
    v_max_u32_dpp v34, v34, v34 row_shr:2 row_mask:0xf bank_mask:0xf bound_ctrl:0
    v_max_u32_dpp v35, v35, v35 row_shr:2 row_mask:0xf bank_mask:0xf bound_ctrl:0
    v_max_u32_dpp v30, v30, v30 row_shr:4 row_mask:0xf bank_mask:0xf bound_ctrl:0
    v_max_u32_dpp v31, v31, v31 row_shr:4 row_mask:0xf bank_mask:0xf bound_ctrl:0
    v_max_u32_dpp v32, v32, v32 row_shr:4 row_mask:0xf bank_mask:0xf bound_ctrl:0
    v_max_u32_dpp v33, v33, v33 row_shr:4 row_mask:0xf bank_mask:0xf bound_ctrl:0
    v_max_u32_dpp v34, v34, v34 row_shr:4 row_mask:0xf bank_mask:0xf bound_ctrl:0
    v_max_u32_dpp v35, v35, v35 row_shr:4 row_mask:0xf bank_mask:0xf bound_ctrl:0
    v_max_u32_dpp v30, v30, v30 row_shr:8 row_mask:0xf bank_mask:0xf bound_ctrl:0
    v_max_u32_dpp v31, v31, v31 row_shr:8 row_mask:0xf bank_mask:0xf bound_ctrl:0
    v_max_u32_dpp v32, v32, v32 row_shr:8 row_mask:0xf bank_mask:0xf bound_ctrl:0
    v_max_u32_dpp v33, v33, v33 row_shr:8 row_mask:0xf bank_mask:0xf bound_ctrl:0
    v_max_u32_dpp v34, v34, v34 row_shr:8 row_mask:0xf bank_mask:0xf bound_ctrl:0
    v_max_u32_dpp v35, v35, v35 row_shr:8 row_mask:0xf bank_mask:0xf bound_ctrl:0
    v_max_u32_dpp v30, v30, v30 row_bcast:15 row_mask:0xa bank_mask:0xf
    v_max_u32_dpp v31, v31, v31 row_bcast:15 row_mask:0xa bank_mask:0xf
    v_max_u32_dpp v32, v32, v32 row_bcast:15 row_mask:0xa bank_mask:0xf
    v_max_u32_dpp v33, v33, v33 row_bcast:15 row_mask:0xa bank_mask:0xf
    v_max_u32_dpp v34, v34, v34 row_bcast:15 row_mask:0xa bank_mask:0xf
    v_max_u32_dpp v35, v35, v35 row_bcast:15 row_mask:0xa bank_mask:0xf
    v_max_u32_dpp v30, v30, v30 row_bcast:31 row_mask:0xc bank_mask:0xf
    v_max_u32_dpp v31, v31, v31 row_bcast:31 row_mask:0xc bank_mask:0xf
    v_max_u32_dpp v32, v32, v32 row_bcast:31 row_mask:0xc bank_mask:0xf
    v_max_u32_dpp v33, v33, v33 row_bcast:31 row_mask:0xc bank_mask:0xf
    v_max_u32_dpp v34, v34, v34 row_bcast:31 row_mask:0xc bank_mask:0xf
    v_max_u32_dpp v35, v35, v35 row_bcast:31 row_mask:0xc bank_mask:0xf
    s_nop 1
    v_add_f32 v30, v30, v33
    v_mul_f32 v31, 4.0, v31
    v_fma_f32 v31, v31, v34, v30
    v_fmac_f32 v31, v32, v35
    v_cmp_gt_f32 vcc, 0x43700000, v31
    v_cmp_lt_f32 s[6:7], -1.0, v10
    v_mov_b32 v32, 0x37800000
    v_cmp_lt_f32 s[4:5], v32, v30
    s_and_b64 vcc, vcc, s[6:7]
    s_and_b64 vcc, vcc, s[4:5]
    s_lshr_b32 s3, vcc_hi, 31
    v_mov_b32 v30, s3
    ds_write_b32 v10, v30 offset:15356
    s_branch L_GUARDD
L_PAD7:
    s_mov_b32 exec_hi, 0
    ds_write2st64_b32 v70, v10, v71 offset0:1 offset1:70
    s_mov_b32 exec_hi, -1
    s_branch L_PLAND
L_PLAN2:
    v_and_b32 v14, 7, v1
    v_lshlrev_b32 v15, 1, v14
    ds_read_u16 v15, v15 offset:15296
    s_lshr_b32 s19, s59, 7
    s_bfe_u32 s20, s59, 0x20005
    s_movk_i32 s3, 185
    s_cmp_lg_u32 s48, 0
    s_cselect_b32 s3, 169, s3
    v_bfe_u32 v16, v1, 3, 2
    v_cmp_gt_u32 vcc, s20, v16
    v_min_u32 v17, s20, v16
    v_mad_u32_u24 v17, v16, s19, v17
    v_mov_b32 v18, s19
    v_addc_co_u32 v18, vcc, 0, v18, vcc
    v_mov_b32 v19, 128
    v_mad_u32_u24 v19, v18, s3, v19
    v_lshrrev_b32 v19, 8, v19
    s_mov_b32 exec_lo, 0
    v_add_u32 v17, v17, v19
    v_sub_u32 v19, v18, v19
    s_mov_b32 exec_lo, -1
    v_lshlrev_b32 v20, 5, v17
    v_add_u32 v27, v17, v19
    v_cmp_ne_u32 s[64:65], 0, v19
    s_waitcnt lgkmcnt(0)
    v_cmp_le_u32 vcc, v15, v20
    v_mov_b32 v21, 0x7fff
    v_cndmask_b32 v27, 0, v27, s[64:65]
    v_cndmask_b32 v21, v15, v21, vcc
    s_and_b32 vcc_lo, vcc_lo, 0x7e7e7e7e
    s_and_b32 vcc_hi, vcc_hi, 0x7e7e7e7e
    v_cndmask_b32 v24, 0, 1, vcc
    v_lshrrev_b32 v28, 3, v1
    v_mov_b32 v26, v17
    v_min_u32_dpp v21, v21, v21 quad_perm:[1,0,3,2] row_mask:0xf bank_mask:0xf
    v_add_u32_dpp v24, v24, v24 quad_perm:[1,0,3,2] row_mask:0xf bank_mask:0xf
    s_nop 0
    v_min_u32_dpp v21, v21, v21 quad_perm:[2,3,0,1] row_mask:0xf bank_mask:0xf
    v_add_u32_dpp v24, v24, v24 quad_perm:[2,3,0,1] row_mask:0xf bank_mask:0xf
    s_nop 0
    v_min_u32_dpp v21, v21, v21 row_half_mirror row_mask:0xf bank_mask:0xf
    v_add_u32_dpp v24, v24, v24 row_half_mirror row_mask:0xf bank_mask:0xf
    s_nop 0
    v_lshrrev_b32 v25, 5, v21
    v_sub_u32 v25, v25, v17
    v_add_u32 v25, -1, v25
    v_lshlrev_b32 v22, 7, v17
    v_add_u32 v22, 79360, v22
    v_mov_b32 v23, v19
    v_lshlrev_b32 v29, 4, v28
    v_lshlrev_b32 v28, 3, v28
    s_mov_b32 exec_lo, 0x01010101
    s_mov_b32 exec_hi, 0x01010101
    ds_write_b128 v29, v[22:25] offset:18176
    ds_write_b64 v28, v[26:27] offset:15232
    s_mov_b64 exec, -1
    s_branch L_PLAND
L_LOPREP:
    v_lshlrev_b32 v75, 1, v1
    ds_read_u16 v75, v75 offset:15296
    v_lshlrev_b32 v70, 3, v1
    ds_read_b64 v[72:73], v70 offset:15232
    s_waitcnt lgkmcnt(0)
    v_lshrrev_b32 v75, 5, v75
    s_mov_b32 m0, s61
    v_readlane_b32 s52, v75, 0
    v_readlane_b32 s53, v75, 1
    v_readlane_b32 s54, v75, 2
    v_readlane_b32 s55, v75, 3
    v_readlane_b32 s56, v75, 4
    v_readlane_b32 s57, v75, 5
    v_readlane_b32 s58, v75, 6
    v_readlane_b32 s59, v75, 7
    s_nop 1
    s_movrels_b32 s19, s52
    s_movrels_b32 s20, s53
    v_cmp_lt_u32 s[72:73], s19, v73
    v_cmp_ge_u32 vcc, s20, v73
    v_cmp_gt_u32 s[74:75], s20, v72
    v_cmp_lt_u32 s[76:77], s20, v73
    s_sub_u32 s65, s20, s19
    s_and_b32 s64, s72, vcc_lo
    s_and_b32 s64, s64, 0xff
    s_and_b32 s3, s74, s76
    s_and_b32 s3, s3, 0xff
    s_cselect_b32 s3, 0x100, 0
    s_or_b32 s64, s64, s3
    s_cmp_eq_u32 s65, 0
    s_cselect_b32 s64, 0, s64
    s_cmp_eq_u32 s61, 7
    s_cselect_b32 s64, 0, s64
    s_lshl_b32 s66, s61, 11
    s_add_u32 s66, s66, 26880
    s_ff1_i32_b32 s3, s64
    s_bitset0_b32 s64, s3
    s_mul_i32 s80, s3, 6144
    s_add_u32 s80, s80, 114688
    s_cmp_eq_u32 s3, 8
    s_cselect_b32 s80, s66, s80
    s_cmp_lt_i32 s3, 0
    s_cselect_b32 s80, 0x30000, s80
    s_ff1_i32_b32 s3, s64
    s_bitset0_b32 s64, s3
    s_mul_i32 s81, s3, 6144
    s_add_u32 s81, s81, 114688
    s_cmp_eq_u32 s3, 8
    s_cselect_b32 s81, s66, s81
    s_cmp_lt_i32 s3, 0
    s_cselect_b32 s81, 0x30000, s81
    s_ff1_i32_b32 s3, s64
    s_bitset0_b32 s64, s3
    s_mul_i32 s82, s3, 6144
    s_add_u32 s82, s82, 114688
    s_cmp_eq_u32 s3, 8
    s_cselect_b32 s82, s66, s82
    s_cmp_lt_i32 s3, 0
    s_cselect_b32 s82, 0x30000, s82
    s_branch L_LOPREPD
L_EVAL:
    s_cmp_eq_u32 s99, 0
    s_cbranch_scc1 L_ADVAL
    ds_read_b128 v[70:73], v236 offset:18432
    ds_read_b128 v[74:77], v236 offset:18464
    ds_read_b128 v[78:81], v236 offset:18496
    ds_read_b128 v[82:85], v236 offset:18528
    ds_read_b128 v[14:17], v236 offset:18560
    ds_read_b128 v[18:21], v236 offset:18592
    ds_read_b128 v[22:25], v236 offset:18624
    ds_read_b128 v[26:29], v236 offset:18656
    v_add_u32 v174, s100, v235
    v_add_u32 v175, s100, v237
    s_mov_b64 exec, s[22:23]
    ds_write_b128 v174, v[102:105] offset:0
    ds_write_b128 v174, v[106:109] offset:32
    ds_write_b128 v174, v[110:113] offset:64
    ds_write_b128 v174, v[114:117] offset:96
    ds_write_b128 v174, v[118:121] offset:128
    ds_write_b128 v174, v[122:125] offset:160
    ds_write_b128 v174, v[126:129] offset:192
    ds_write_b128 v174, v[130:133] offset:224
    s_mov_b64 exec, -1
    s_waitcnt lgkmcnt(8)
    v_pk_mul_f32 v[70:71], v[70:71], v[102:103]
    v_pk_mul_f32 v[72:73], v[72:73], v[104:105]
    v_pk_mul_f32 v[74:75], v[74:75], v[106:107]
    v_pk_mul_f32 v[76:77], v[76:77], v[108:109]
    v_pk_mul_f32 v[78:79], v[78:79], v[110:111]
    v_pk_mul_f32 v[80:81], v[80:81], v[112:113]
    v_pk_mul_f32 v[82:83], v[82:83], v[114:115]
    v_pk_mul_f32 v[84:85], v[84:85], v[116:117]
    v_pk_fma_f32 v[70:71], v[14:15], v[118:119], v[70:71]
    v_pk_fma_f32 v[72:73], v[16:17], v[120:121], v[72:73]
    v_pk_fma_f32 v[74:75], v[18:19], v[122:123], v[74:75]
    v_pk_fma_f32 v[76:77], v[20:21], v[124:125], v[76:77]
    v_pk_fma_f32 v[78:79], v[22:23], v[126:127], v[78:79]
    v_pk_fma_f32 v[80:81], v[24:25], v[128:129], v[80:81]
    v_pk_fma_f32 v[82:83], v[26:27], v[130:131], v[82:83]
    v_pk_fma_f32 v[84:85], v[28:29], v[132:133], v[84:85]
    v_pk_add_f32 v[70:71], v[70:71], v[78:79]
    v_pk_add_f32 v[72:73], v[72:73], v[80:81]
    v_pk_add_f32 v[74:75], v[74:75], v[82:83]
    v_pk_add_f32 v[76:77], v[76:77], v[84:85]
    v_pk_add_f32 v[70:71], v[70:71], v[74:75]
    v_pk_add_f32 v[72:73], v[72:73], v[76:77]
    v_pk_add_f32 v[70:71], v[70:71], v[72:73]
    v_add_f32 v70, v70, v71
    ds_write_b32 v175, v70 offset:1792
    v_mfma_f32_32x32x16_bf16 v[102:117], v[10:13], v[10:13], 0
    v_mfma_f32_32x32x16_bf16 v[118:133], v[10:13], v[10:13], 0
    s_lshl_b32 s100, s97, 11
    s_add_u32 s100, s100, 26880
    s_sub_u32 s98, s99, 2
    s_mov_b32 s99, 0
    s_cbranch_scc0 L_NOADVAL
L_ADVAL:
    s_cmp_ge_u32 s97, 6
    s_cbranch_scc1 L_NOADVAL
    s_add_u32 s97, s97, 1
    s_mov_b32 m0, s97
    s_nop 0
    s_movrels_b32 s19, s52
    s_movrels_b32 s99, s53
    s_sub_u32 s99, s99, s19
    s_cmp_eq_u32 s99, 0
    s_cbranch_scc1 L_ADVAL
    s_mov_b32 s98, 0
    v_mad_u32_u24 v232, v234, s97, v233
    ds_read_b128 v[2:5], v232 offset:0
    ds_read_b128 v[6:9], v232 offset:512
    s_branch L_NOADVAL
L_EVBL:
    s_cmp_eq_u32 s99, 0
    s_cbranch_scc1 L_ADVBL
    ds_read_b128 v[70:73], v236 offset:18432
    ds_read_b128 v[74:77], v236 offset:18464
    ds_read_b128 v[78:81], v236 offset:18496
    ds_read_b128 v[82:85], v236 offset:18528
    ds_read_b128 v[14:17], v236 offset:18560
    ds_read_b128 v[18:21], v236 offset:18592
    ds_read_b128 v[22:25], v236 offset:18624
    ds_read_b128 v[26:29], v236 offset:18656
    v_add_u32 v174, s100, v235
    v_add_u32 v175, s100, v237
    s_mov_b64 exec, s[22:23]
    ds_write_b128 v174, v[102:105] offset:0
    ds_write_b128 v174, v[106:109] offset:32
    ds_write_b128 v174, v[110:113] offset:64
    ds_write_b128 v174, v[114:117] offset:96
    ds_write_b128 v174, v[118:121] offset:128
    ds_write_b128 v174, v[122:125] offset:160
    ds_write_b128 v174, v[126:129] offset:192
    ds_write_b128 v174, v[130:133] offset:224
    s_mov_b64 exec, -1
    s_waitcnt lgkmcnt(8)
    v_pk_mul_f32 v[70:71], v[70:71], v[102:103]
    v_pk_mul_f32 v[72:73], v[72:73], v[104:105]
    v_pk_mul_f32 v[74:75], v[74:75], v[106:107]
    v_pk_mul_f32 v[76:77], v[76:77], v[108:109]
    v_pk_mul_f32 v[78:79], v[78:79], v[110:111]
    v_pk_mul_f32 v[80:81], v[80:81], v[112:113]
    v_pk_mul_f32 v[82:83], v[82:83], v[114:115]
    v_pk_mul_f32 v[84:85], v[84:85], v[116:117]
    v_pk_fma_f32 v[70:71], v[14:15], v[118:119], v[70:71]
    v_pk_fma_f32 v[72:73], v[16:17], v[120:121], v[72:73]
    v_pk_fma_f32 v[74:75], v[18:19], v[122:123], v[74:75]
    v_pk_fma_f32 v[76:77], v[20:21], v[124:125], v[76:77]
    v_pk_fma_f32 v[78:79], v[22:23], v[126:127], v[78:79]
    v_pk_fma_f32 v[80:81], v[24:25], v[128:129], v[80:81]
    v_pk_fma_f32 v[82:83], v[26:27], v[130:131], v[82:83]
    v_pk_fma_f32 v[84:85], v[28:29], v[132:133], v[84:85]
    v_pk_add_f32 v[70:71], v[70:71], v[78:79]
    v_pk_add_f32 v[72:73], v[72:73], v[80:81]
    v_pk_add_f32 v[74:75], v[74:75], v[82:83]
    v_pk_add_f32 v[76:77], v[76:77], v[84:85]
    v_pk_add_f32 v[70:71], v[70:71], v[74:75]
    v_pk_add_f32 v[72:73], v[72:73], v[76:77]
    v_pk_add_f32 v[70:71], v[70:71], v[72:73]
    v_add_f32 v70, v70, v71
    ds_write_b32 v175, v70 offset:1792
    v_mfma_f32_32x32x16_bf16 v[102:117], v[10:13], v[10:13], 0
    v_mfma_f32_32x32x16_bf16 v[118:133], v[10:13], v[10:13], 0
    s_lshl_b32 s100, s97, 11
    s_add_u32 s100, s100, 26880
    s_sub_u32 s98, s99, 2
    s_mov_b32 s99, 0
    s_cbranch_scc0 L_NOADVBL
L_ADVBL:
    s_cmp_ge_u32 s97, 6
    s_cbranch_scc1 L_NOADVBL
    s_add_u32 s97, s97, 1
    s_mov_b32 m0, s97
    s_nop 0
    s_movrels_b32 s19, s52
    s_movrels_b32 s99, s53
    s_sub_u32 s99, s99, s19
    s_cmp_eq_u32 s99, 0
    s_cbranch_scc1 L_ADVBL
    s_mov_b32 s98, 0
    v_mad_u32_u24 v232, v234, s97, v233
    ds_read_b128 v[2:5], v232 offset:0
    ds_read_b128 v[6:9], v232 offset:512
    s_branch L_NOADVBL
CODE_LAST:
L_POLLR:
    s_add_u32 s96, s96, 1
    s_cmp_gt_u32 s96, 100000
    s_cbranch_scc1 L_ABORT
    buffer_load_dwordx4 v[86:89], v223, s[36:39], s14 offen sc1
    buffer_load_dwordx4 v[90:93], v223, s[36:39], s15 offen sc1
    buffer_load_dwordx4 v[94:97], v223, s[36:39], s16 offen sc1
    buffer_load_dwordx4 v[98:101], v223, s[36:39], s17 offen sc1
    s_branch L_POLL
L_RETRY:
    s_add_u32 s96, s96, 1
    s_cmp_gt_u32 s96, 100000
    s_cbranch_scc1 L_ABORT
    v_mov_b32 v164, s50
    v_mov_b32 v165, 0x3800
    v_mov_b32 v166, s51
    v_mov_b32 v167, 0x3800
    v_pk_mov_b32 v[102:103], v[164:165], v[164:165] op_sel:[0,1]
    v_pk_mov_b32 v[104:105], v[166:167], v[166:167] op_sel:[0,1]
    v_pk_mov_b32 v[106:107], v[164:165], v[164:165] op_sel:[0,1]
    v_pk_mov_b32 v[108:109], v[166:167], v[166:167] op_sel:[0,1]
    v_pk_mov_b32 v[110:111], v[164:165], v[164:165] op_sel:[0,1]
    v_pk_mov_b32 v[112:113], v[166:167], v[166:167] op_sel:[0,1]
    v_pk_mov_b32 v[114:115], v[164:165], v[164:165] op_sel:[0,1]
    v_pk_mov_b32 v[116:117], v[166:167], v[166:167] op_sel:[0,1]
    v_pk_mov_b32 v[118:119], v[164:165], v[164:165] op_sel:[0,1]
    v_pk_mov_b32 v[120:121], v[166:167], v[166:167] op_sel:[0,1]
    v_pk_mov_b32 v[122:123], v[164:165], v[164:165] op_sel:[0,1]
    v_pk_mov_b32 v[124:125], v[166:167], v[166:167] op_sel:[0,1]
    v_pk_mov_b32 v[126:127], v[164:165], v[164:165] op_sel:[0,1]
    v_pk_mov_b32 v[128:129], v[166:167], v[166:167] op_sel:[0,1]
    v_pk_mov_b32 v[130:131], v[164:165], v[164:165] op_sel:[0,1]
    v_pk_mov_b32 v[132:133], v[166:167], v[166:167] op_sel:[0,1]
    s_branch L_ROUND
L_SHRINK:
    s_cmp_lg_u32 s3, 0
    s_cbranch_scc1 L_END
    s_cmp_eq_u32 s27, 16
    s_cbranch_scc1 L_FITS
    s_mov_b32 s27, 16
    s_mov_b32 s46, 0x7fffffff
    s_waitcnt lgkmcnt(0)
    s_barrier
    s_branch L_AGAIN
L_IDLE:
    v_lshlrev_b32 v75, 1, v1
    ds_read_u16 v75, v75 offset:15296
    v_lshlrev_b32 v70, 3, v1
    ds_read_b64 v[72:73], v70 offset:15232
    s_waitcnt lgkmcnt(0)
    v_lshrrev_b32 v75, 5, v75
    s_mov_b32 m0, s61
    v_readlane_b32 s52, v75, 0
    v_readlane_b32 s53, v75, 1
    v_readlane_b32 s54, v75, 2
    v_readlane_b32 s55, v75, 3
    v_readlane_b32 s56, v75, 4
    v_readlane_b32 s57, v75, 5
    v_readlane_b32 s58, v75, 6
    v_readlane_b32 s59, v75, 7
    s_nop 1
    s_movrels_b32 s19, s52
    s_movrels_b32 s20, s53
    v_cmp_lt_u32 s[72:73], s19, v73
    v_cmp_ge_u32 vcc, s20, v73
    v_cmp_gt_u32 s[74:75], s20, v72
    v_cmp_lt_u32 s[76:77], s20, v73
    s_sub_u32 s65, s20, s19
    s_and_b32 s64, s72, vcc_lo
    s_and_b32 s64, s64, 0xff
    s_and_b32 s3, s74, s76
    s_and_b32 s3, s3, 0xff
    s_cselect_b32 s3, 0x100, 0
    s_or_b32 s64, s64, s3
    s_cmp_eq_u32 s65, 0
    s_cselect_b32 s64, 0, s64
    s_cmp_eq_u32 s61, 7
    s_cselect_b32 s64, 0, s64
    s_lshl_b32 s66, s61, 11
    s_add_u32 s66, s66, 26880
    s_ff1_i32_b32 s3, s64
    s_bitset0_b32 s64, s3
    s_mul_i32 s80, s3, 6144
    s_add_u32 s80, s80, 114688
    s_cmp_eq_u32 s3, 8
    s_cselect_b32 s80, s66, s80
    s_cmp_lt_i32 s3, 0
    s_cselect_b32 s80, 0x30000, s80
    s_ff1_i32_b32 s3, s64
    s_bitset0_b32 s64, s3
    s_mul_i32 s81, s3, 6144
    s_add_u32 s81, s81, 114688
    s_cmp_eq_u32 s3, 8
    s_cselect_b32 s81, s66, s81
    s_cmp_lt_i32 s3, 0
    s_cselect_b32 s81, 0x30000, s81
    s_ff1_i32_b32 s3, s64
    s_bitset0_b32 s64, s3
    s_mul_i32 s82, s3, 6144
    s_add_u32 s82, s82, 114688
    s_cmp_eq_u32 s3, 8
    s_cselect_b32 s82, s66, s82
    s_cmp_lt_i32 s3, 0
    s_cselect_b32 s82, 0x30000, s82
    s_branch L_DONE
L_EVA:
    s_cmp_eq_u32 s99, 0
    s_cbranch_scc1 L_ADVA
    ds_read_b128 v[70:73], v236 offset:18432
    ds_read_b128 v[74:77], v236 offset:18464
    ds_read_b128 v[78:81], v236 offset:18496
    ds_read_b128 v[82:85], v236 offset:18528
    ds_read_b128 v[14:17], v236 offset:18560
    ds_read_b128 v[18:21], v236 offset:18592
    ds_read_b128 v[22:25], v236 offset:18624
    ds_read_b128 v[26:29], v236 offset:18656
    v_add_u32 v174, s100, v235
    v_add_u32 v175, s100, v237
    s_mov_b64 exec, s[22:23]
    ds_write_b128 v174, v[102:105] offset:0
    ds_write_b128 v174, v[106:109] offset:32
    ds_write_b128 v174, v[110:113] offset:64
    ds_write_b128 v174, v[114:117] offset:96
    ds_write_b128 v174, v[118:121] offset:128
    ds_write_b128 v174, v[122:125] offset:160
    ds_write_b128 v174, v[126:129] offset:192
    ds_write_b128 v174, v[130:133] offset:224
    s_mov_b64 exec, -1
    s_waitcnt lgkmcnt(8)
    v_pk_mul_f32 v[70:71], v[70:71], v[102:103]
    v_pk_mul_f32 v[72:73], v[72:73], v[104:105]
    v_pk_mul_f32 v[74:75], v[74:75], v[106:107]
    v_pk_mul_f32 v[76:77], v[76:77], v[108:109]
    v_pk_mul_f32 v[78:79], v[78:79], v[110:111]
    v_pk_mul_f32 v[80:81], v[80:81], v[112:113]
    v_pk_mul_f32 v[82:83], v[82:83], v[114:115]
    v_pk_mul_f32 v[84:85], v[84:85], v[116:117]
    v_pk_fma_f32 v[70:71], v[14:15], v[118:119], v[70:71]
    v_pk_fma_f32 v[72:73], v[16:17], v[120:121], v[72:73]
    v_pk_fma_f32 v[74:75], v[18:19], v[122:123], v[74:75]
    v_pk_fma_f32 v[76:77], v[20:21], v[124:125], v[76:77]
    v_pk_fma_f32 v[78:79], v[22:23], v[126:127], v[78:79]
    v_pk_fma_f32 v[80:81], v[24:25], v[128:129], v[80:81]
    v_pk_fma_f32 v[82:83], v[26:27], v[130:131], v[82:83]
    v_pk_fma_f32 v[84:85], v[28:29], v[132:133], v[84:85]
    v_pk_add_f32 v[70:71], v[70:71], v[78:79]
    v_pk_add_f32 v[72:73], v[72:73], v[80:81]
    v_pk_add_f32 v[74:75], v[74:75], v[82:83]
    v_pk_add_f32 v[76:77], v[76:77], v[84:85]
    v_pk_add_f32 v[70:71], v[70:71], v[74:75]
    v_pk_add_f32 v[72:73], v[72:73], v[76:77]
    v_pk_add_f32 v[70:71], v[70:71], v[72:73]
    v_add_f32 v70, v70, v71
    ds_write_b32 v175, v70 offset:1792
    v_mfma_f32_32x32x16_bf16 v[102:117], v[10:13], v[10:13], 0
    v_mfma_f32_32x32x16_bf16 v[118:133], v[10:13], v[10:13], 0
    s_lshl_b32 s100, s97, 11
    s_add_u32 s100, s100, 26880
    s_sub_u32 s98, s99, 2
    s_mov_b32 s99, 0
    s_cbranch_scc0 L_NOADVA
L_ADVA:
    s_cmp_ge_u32 s97, 6
    s_cbranch_scc1 L_NOADVA
    s_add_u32 s97, s97, 1
    s_mov_b32 m0, s97
    s_nop 0
    s_movrels_b32 s19, s52
    s_movrels_b32 s99, s53
    s_sub_u32 s99, s99, s19
    s_cmp_eq_u32 s99, 0
    s_cbranch_scc1 L_ADVA
    s_mov_b32 s98, 0
    v_mad_u32_u24 v232, v234, s97, v233
    ds_read_b128 v[2:5], v232 offset:0
    ds_read_b128 v[6:9], v232 offset:512
    s_branch L_NOADVA
L_EVB:
    s_cmp_eq_u32 s99, 0
    s_cbranch_scc1 L_ADVB
    ds_read_b128 v[70:73], v236 offset:18432
    ds_read_b128 v[74:77], v236 offset:18464
    ds_read_b128 v[78:81], v236 offset:18496
    ds_read_b128 v[82:85], v236 offset:18528
    ds_read_b128 v[14:17], v236 offset:18560
    ds_read_b128 v[18:21], v236 offset:18592
    ds_read_b128 v[22:25], v236 offset:18624
    ds_read_b128 v[26:29], v236 offset:18656
    v_add_u32 v174, s100, v235
    v_add_u32 v175, s100, v237
    s_mov_b64 exec, s[22:23]
    ds_write_b128 v174, v[102:105] offset:0
    ds_write_b128 v174, v[106:109] offset:32
    ds_write_b128 v174, v[110:113] offset:64
    ds_write_b128 v174, v[114:117] offset:96
    ds_write_b128 v174, v[118:121] offset:128
    ds_write_b128 v174, v[122:125] offset:160
    ds_write_b128 v174, v[126:129] offset:192
    ds_write_b128 v174, v[130:133] offset:224
    s_mov_b64 exec, -1
    s_waitcnt lgkmcnt(8)
    v_pk_mul_f32 v[70:71], v[70:71], v[102:103]
    v_pk_mul_f32 v[72:73], v[72:73], v[104:105]
    v_pk_mul_f32 v[74:75], v[74:75], v[106:107]
    v_pk_mul_f32 v[76:77], v[76:77], v[108:109]
    v_pk_mul_f32 v[78:79], v[78:79], v[110:111]
    v_pk_mul_f32 v[80:81], v[80:81], v[112:113]
    v_pk_mul_f32 v[82:83], v[82:83], v[114:115]
    v_pk_mul_f32 v[84:85], v[84:85], v[116:117]
    v_pk_fma_f32 v[70:71], v[14:15], v[118:119], v[70:71]
    v_pk_fma_f32 v[72:73], v[16:17], v[120:121], v[72:73]
    v_pk_fma_f32 v[74:75], v[18:19], v[122:123], v[74:75]
    v_pk_fma_f32 v[76:77], v[20:21], v[124:125], v[76:77]
    v_pk_fma_f32 v[78:79], v[22:23], v[126:127], v[78:79]
    v_pk_fma_f32 v[80:81], v[24:25], v[128:129], v[80:81]
    v_pk_fma_f32 v[82:83], v[26:27], v[130:131], v[82:83]
    v_pk_fma_f32 v[84:85], v[28:29], v[132:133], v[84:85]
    v_pk_add_f32 v[70:71], v[70:71], v[78:79]
    v_pk_add_f32 v[72:73], v[72:73], v[80:81]
    v_pk_add_f32 v[74:75], v[74:75], v[82:83]
    v_pk_add_f32 v[76:77], v[76:77], v[84:85]
    v_pk_add_f32 v[70:71], v[70:71], v[74:75]
    v_pk_add_f32 v[72:73], v[72:73], v[76:77]
    v_pk_add_f32 v[70:71], v[70:71], v[72:73]
    v_add_f32 v70, v70, v71
    ds_write_b32 v175, v70 offset:1792
    v_mfma_f32_32x32x16_bf16 v[102:117], v[10:13], v[10:13], 0
    v_mfma_f32_32x32x16_bf16 v[118:133], v[10:13], v[10:13], 0
    s_lshl_b32 s100, s97, 11
    s_add_u32 s100, s100, 26880
    s_sub_u32 s98, s99, 2
    s_mov_b32 s99, 0
    s_cbranch_scc0 L_NOADVB
L_ADVB:
    s_cmp_ge_u32 s97, 6
    s_cbranch_scc1 L_NOADVB
    s_add_u32 s97, s97, 1
    s_mov_b32 m0, s97
    s_nop 0
    s_movrels_b32 s19, s52
    s_movrels_b32 s99, s53
    s_sub_u32 s99, s99, s19
    s_cmp_eq_u32 s99, 0
    s_cbranch_scc1 L_ADVB
    s_mov_b32 s98, 0
    v_mad_u32_u24 v232, v234, s97, v233
    ds_read_b128 v[2:5], v232 offset:0
    ds_read_b128 v[6:9], v232 offset:512
    s_branch L_NOADVB
    .p2align 3
L_LOOP:
    s_waitcnt lgkmcnt(0)
    buffer_load_dword v46, v134, s[28:31], 0 offen sc1
    buffer_load_dword v47, v135, s[28:31], 0 offen sc1
    buffer_load_dword v48, v136, s[28:31], 0 offen sc1
    buffer_load_dword v49, v137, s[28:31], 0 offen sc1
    buffer_load_dword v50, v138, s[28:31], 0 offen sc1
    buffer_load_dword v51, v139, s[28:31], 0 offen sc1
    buffer_load_dword v52, v140, s[28:31], 0 offen sc1
    buffer_load_dword v53, v141, s[28:31], 0 offen sc1
    buffer_load_dword v54, v142, s[28:31], 0 offen sc1
    buffer_load_dword v55, v143, s[28:31], 0 offen sc1
    buffer_load_dword v56, v144, s[28:31], 0 offen sc1
    buffer_load_dword v57, v145, s[28:31], 0 offen sc1
    buffer_load_dword v58, v146, s[28:31], 0 offen sc1
    buffer_load_dword v59, v147, s[28:31], 0 offen sc1
    buffer_load_dword v60, v148, s[28:31], 0 offen sc1
    buffer_load_dword v61, v149, s[28:31], 0 offen sc1
    ds_read_b128 v[134:137], v227 offset:256
    ds_read_b128 v[138:141], v227 offset:288
    ds_read_b128 v[142:145], v227 offset:320
    ds_read_b128 v[146:149], v227 offset:352
    ds_read2st64_b32 v[162:163], v226 offset0:0 offset1:69
    v_mfma_f32_32x32x16_bf16 v[102:117], v[86:89], v[150:153], v[102:117]
    v_exp_f32 v70, v14
    v_exp_f32 v71, v15
    v_exp_f32 v72, v16
    v_exp_f32 v73, v17
    v_mfma_f32_32x32x16_bf16 v[118:133], v[94:97], v[150:153], v[118:133]
    v_exp_f32 v74, v18
    v_exp_f32 v75, v19
    v_exp_f32 v76, v20
    v_exp_f32 v77, v21
    v_exp_f32 v78, v22
    v_exp_f32 v79, v23
    v_exp_f32 v80, v24
    v_exp_f32 v81, v25
    v_exp_f32 v82, v26
    v_exp_f32 v83, v27
    v_exp_f32 v84, v28
    v_exp_f32 v85, v29
    v_pk_add_f32 v[70:71], v[70:71], 1.0 op_sel_hi:[1,0]
    v_pk_add_f32 v[72:73], v[72:73], 1.0 op_sel_hi:[1,0]
    v_pk_add_f32 v[74:75], v[74:75], 1.0 op_sel_hi:[1,0]
    v_pk_add_f32 v[76:77], v[76:77], 1.0 op_sel_hi:[1,0]
    v_pk_add_f32 v[78:79], v[78:79], 1.0 op_sel_hi:[1,0]
    v_pk_add_f32 v[80:81], v[80:81], 1.0 op_sel_hi:[1,0]
    v_pk_add_f32 v[82:83], v[82:83], 1.0 op_sel_hi:[1,0]
    v_pk_add_f32 v[84:85], v[84:85], 1.0 op_sel_hi:[1,0]
    v_mfma_f32_32x32x16_bf16 v[102:117], v[90:93], v[154:157], v[102:117]
    v_rcp_f32 v70, v70
    v_rcp_f32 v71, v71
    v_rcp_f32 v72, v72
    v_rcp_f32 v73, v73
    v_mfma_f32_32x32x16_bf16 v[118:133], v[98:101], v[154:157], v[118:133]
    v_rcp_f32 v74, v74
    v_rcp_f32 v75, v75
    v_rcp_f32 v76, v76
    v_rcp_f32 v77, v77
    v_rcp_f32 v78, v78
    v_rcp_f32 v79, v79
    v_rcp_f32 v80, v80
    v_rcp_f32 v81, v81
    v_rcp_f32 v82, v82
    v_rcp_f32 v83, v83
    v_rcp_f32 v84, v84
    v_rcp_f32 v85, v85
    v_pk_mul_f32 v[70:71], v[70:71], v[14:15]
    v_pk_mul_f32 v[72:73], v[72:73], v[16:17]
    v_pk_mul_f32 v[74:75], v[74:75], v[18:19]
    v_pk_mul_f32 v[76:77], v[76:77], v[20:21]
    v_pk_mul_f32 v[78:79], v[78:79], v[22:23]
    v_pk_mul_f32 v[80:81], v[80:81], v[24:25]
    v_pk_mul_f32 v[82:83], v[82:83], v[26:27]
    v_pk_mul_f32 v[84:85], v[84:85], v[28:29]
    v_cvt_pk_bf16_f32 v86, v70, v71
    v_cvt_pk_bf16_f32 v87, v72, v73
    v_cvt_pk_bf16_f32 v88, v74, v75
    v_cvt_pk_bf16_f32 v89, v76, v77
    v_cvt_pk_bf16_f32 v90, v78, v79
    v_cvt_pk_bf16_f32 v91, v80, v81
    v_cvt_pk_bf16_f32 v92, v82, v83
    v_cvt_pk_bf16_f32 v93, v84, v85
    s_waitcnt lgkmcnt(0)
    v_lshlrev_b32_sdwa v224, 4, v163 dst_sel:DWORD dst_unused:UNUSED_PAD src0_sel:DWORD src1_sel:BYTE_1
    s_sub_u32 s98, s98, 1
    s_cbranch_scc1 L_EVA
L_NOADVA:
    buffer_load_dwordx3 v[164:166], v162, s[32:35], 0 idxen sc1
    ds_read_b128 v[168:171], v224 offset:14336
    ds_read_b128 v[158:161], v228 offset:512
    ds_read_b64_tr_b16 v[150:151], v229 offset:0
    ds_read_b64_tr_b16 v[152:153], v229 offset:512
    ds_read_b64_tr_b16 v[154:155], v229 offset:1024
    ds_read_b64_tr_b16 v[156:157], v229 offset:1536
    v_exp_f32 v70, v30
    v_exp_f32 v71, v31
    v_exp_f32 v72, v32
    v_exp_f32 v73, v33
    v_exp_f32 v74, v34
    v_exp_f32 v75, v35
    v_exp_f32 v76, v36
    v_exp_f32 v77, v37
    v_exp_f32 v78, v38
    v_exp_f32 v79, v39
    v_exp_f32 v80, v40
    v_exp_f32 v81, v41
    v_exp_f32 v82, v42
    v_exp_f32 v83, v43
    v_exp_f32 v84, v44
    v_exp_f32 v85, v45
    v_pk_add_f32 v[70:71], v[70:71], 1.0 op_sel_hi:[1,0]
    v_pk_add_f32 v[72:73], v[72:73], 1.0 op_sel_hi:[1,0]
    v_pk_add_f32 v[74:75], v[74:75], 1.0 op_sel_hi:[1,0]
    v_pk_add_f32 v[76:77], v[76:77], 1.0 op_sel_hi:[1,0]
    v_pk_add_f32 v[78:79], v[78:79], 1.0 op_sel_hi:[1,0]
    v_pk_add_f32 v[80:81], v[80:81], 1.0 op_sel_hi:[1,0]
    v_pk_add_f32 v[82:83], v[82:83], 1.0 op_sel_hi:[1,0]
    v_pk_add_f32 v[84:85], v[84:85], 1.0 op_sel_hi:[1,0]
    s_waitcnt vmcnt(1) lgkmcnt(4)
    v_lshlrev_b32 v14, 16, v46
    v_lshlrev_b32 v15, 16, v47
    v_lshlrev_b32 v16, 16, v48
    v_lshlrev_b32 v17, 16, v49
    v_lshlrev_b32 v18, 16, v50
    v_lshlrev_b32 v19, 16, v51
    v_lshlrev_b32 v20, 16, v52
    v_lshlrev_b32 v21, 16, v53
    v_lshlrev_b32 v22, 16, v54
    v_lshlrev_b32 v23, 16, v55
    v_lshlrev_b32 v24, 16, v56
    v_lshlrev_b32 v25, 16, v57
    v_lshlrev_b32 v26, 16, v58
    v_lshlrev_b32 v27, 16, v59
    v_lshlrev_b32 v28, 16, v60
    v_lshlrev_b32 v29, 16, v61
    v_rcp_f32 v70, v70
    v_rcp_f32 v71, v71
    v_mfma_f32_32x32x16_bf16 v[14:29], v[158:161], v[2:5], v[14:29]
    v_rcp_f32 v72, v72
    v_rcp_f32 v73, v73
    v_rcp_f32 v74, v74
    v_rcp_f32 v75, v75
    v_mfma_f32_32x32x16_bf16 v[46:61], v[158:161], v[6:9], v[46:61]
    v_rcp_f32 v76, v76
    v_rcp_f32 v77, v77
    v_rcp_f32 v78, v78
    v_rcp_f32 v79, v79
    v_rcp_f32 v80, v80
    v_rcp_f32 v81, v81
    v_rcp_f32 v82, v82
    v_rcp_f32 v83, v83
    v_rcp_f32 v84, v84
    v_rcp_f32 v85, v85
    v_pk_mul_f32 v[70:71], v[70:71], v[30:31]
    v_pk_mul_f32 v[72:73], v[72:73], v[32:33]
    v_pk_mul_f32 v[74:75], v[74:75], v[34:35]
    v_pk_mul_f32 v[76:77], v[76:77], v[36:37]
    v_pk_mul_f32 v[78:79], v[78:79], v[38:39]
    v_pk_mul_f32 v[80:81], v[80:81], v[40:41]
    v_pk_mul_f32 v[82:83], v[82:83], v[42:43]
    v_pk_mul_f32 v[84:85], v[84:85], v[44:45]
    v_cvt_pk_bf16_f32 v94, v70, v71
    v_cvt_pk_bf16_f32 v95, v72, v73
    v_cvt_pk_bf16_f32 v96, v74, v75
    v_cvt_pk_bf16_f32 v97, v76, v77
    v_cvt_pk_bf16_f32 v98, v78, v79
    v_cvt_pk_bf16_f32 v99, v80, v81
    v_cvt_pk_bf16_f32 v100, v82, v83
    v_cvt_pk_bf16_f32 v101, v84, v85
    s_sub_u32 s96, s96, 1
    s_cbranch_scc1 L_DRAIN
    s_waitcnt lgkmcnt(0)
    buffer_load_dword v30, v134, s[28:31], 0 offen sc1
    buffer_load_dword v31, v135, s[28:31], 0 offen sc1
    buffer_load_dword v32, v136, s[28:31], 0 offen sc1
    buffer_load_dword v33, v137, s[28:31], 0 offen sc1
    buffer_load_dword v34, v138, s[28:31], 0 offen sc1
    buffer_load_dword v35, v139, s[28:31], 0 offen sc1
    buffer_load_dword v36, v140, s[28:31], 0 offen sc1
    buffer_load_dword v37, v141, s[28:31], 0 offen sc1
    buffer_load_dword v38, v142, s[28:31], 0 offen sc1
    buffer_load_dword v39, v143, s[28:31], 0 offen sc1
    buffer_load_dword v40, v144, s[28:31], 0 offen sc1
    buffer_load_dword v41, v145, s[28:31], 0 offen sc1
    buffer_load_dword v42, v146, s[28:31], 0 offen sc1
    buffer_load_dword v43, v147, s[28:31], 0 offen sc1
    buffer_load_dword v44, v148, s[28:31], 0 offen sc1
    buffer_load_dword v45, v149, s[28:31], 0 offen sc1
    ds_read_b128 v[134:137], v227 offset:384
    ds_read_b128 v[138:141], v227 offset:416
    ds_read_b128 v[142:145], v227 offset:448
    ds_read_b128 v[146:149], v227 offset:480
    v_mfma_f32_32x32x16_bf16 v[102:117], v[86:89], v[150:153], v[102:117]
    v_exp_f32 v70, v14
    v_exp_f32 v71, v15
    v_exp_f32 v72, v16
    v_exp_f32 v73, v17
    v_mfma_f32_32x32x16_bf16 v[118:133], v[94:97], v[150:153], v[118:133]
    v_exp_f32 v74, v18
    v_exp_f32 v75, v19
    v_exp_f32 v76, v20
    v_exp_f32 v77, v21
    v_exp_f32 v78, v22
    v_exp_f32 v79, v23
    v_exp_f32 v80, v24
    v_exp_f32 v81, v25
    v_exp_f32 v82, v26
    v_exp_f32 v83, v27
    v_exp_f32 v84, v28
    v_exp_f32 v85, v29
    v_pk_add_f32 v[70:71], v[70:71], 1.0 op_sel_hi:[1,0]
    v_pk_add_f32 v[72:73], v[72:73], 1.0 op_sel_hi:[1,0]
    v_pk_add_f32 v[74:75], v[74:75], 1.0 op_sel_hi:[1,0]
    v_pk_add_f32 v[76:77], v[76:77], 1.0 op_sel_hi:[1,0]
    v_pk_add_f32 v[78:79], v[78:79], 1.0 op_sel_hi:[1,0]
    v_pk_add_f32 v[80:81], v[80:81], 1.0 op_sel_hi:[1,0]
    v_pk_add_f32 v[82:83], v[82:83], 1.0 op_sel_hi:[1,0]
    v_pk_add_f32 v[84:85], v[84:85], 1.0 op_sel_hi:[1,0]
    v_mfma_f32_32x32x16_bf16 v[102:117], v[90:93], v[154:157], v[102:117]
    v_rcp_f32 v70, v70
    v_rcp_f32 v71, v71
    v_rcp_f32 v72, v72
    v_rcp_f32 v73, v73
    v_mfma_f32_32x32x16_bf16 v[118:133], v[98:101], v[154:157], v[118:133]
    v_rcp_f32 v74, v74
    v_rcp_f32 v75, v75
    v_rcp_f32 v76, v76
    v_rcp_f32 v77, v77
    v_rcp_f32 v78, v78
    v_rcp_f32 v79, v79
    v_rcp_f32 v80, v80
    v_rcp_f32 v81, v81
    v_rcp_f32 v82, v82
    v_rcp_f32 v83, v83
    v_rcp_f32 v84, v84
    v_rcp_f32 v85, v85
    v_pk_mul_f32 v[70:71], v[70:71], v[14:15]
    v_pk_mul_f32 v[72:73], v[72:73], v[16:17]
    v_pk_mul_f32 v[74:75], v[74:75], v[18:19]
    v_pk_mul_f32 v[76:77], v[76:77], v[20:21]
    v_pk_mul_f32 v[78:79], v[78:79], v[22:23]
    v_pk_mul_f32 v[80:81], v[80:81], v[24:25]
    v_pk_mul_f32 v[82:83], v[82:83], v[26:27]
    v_pk_mul_f32 v[84:85], v[84:85], v[28:29]
    v_cvt_pk_bf16_f32 v86, v70, v71
    v_cvt_pk_bf16_f32 v87, v72, v73
    v_cvt_pk_bf16_f32 v88, v74, v75
    v_cvt_pk_bf16_f32 v89, v76, v77
    v_cvt_pk_bf16_f32 v90, v78, v79
    v_cvt_pk_bf16_f32 v91, v80, v81
    v_cvt_pk_bf16_f32 v92, v82, v83
    v_cvt_pk_bf16_f32 v93, v84, v85
    s_waitcnt vmcnt(16)
    v_pk_add_f32 v[168:169], v[168:169], v[164:165] neg_lo:[0,1] neg_hi:[0,1]
    v_sub_f32 v170, v170, v166
    v_mul_f32 v224, v168, v168
    v_cvt_pk_bf16_f32 v172, 1.0, v168
    v_fmac_f32 v224, v169, v169
    v_cvt_pk_bf16_f32 v173, v169, v170
    v_fmac_f32 v224, v170, v170
    v_lshrrev_b32_sdwa v171, 2, v163 dst_sel:DWORD dst_unused:UNUSED_PAD src0_sel:DWORD src1_sel:BYTE_0
    v_cvt_pk_bf16_f32 v223, v224, v163
    v_add_u32_sdwa v164, v230, v163 dst_sel:DWORD dst_unused:UNUSED_PAD src0_sel:DWORD src1_sel:BYTE_0
    v_add_u32 v165, v231, v171
    v_add_u32 v226, 256, v226
    v_add_u32 v227, 256, v227
    s_sub_u32 s98, s98, 1
    s_cbranch_scc1 L_EVB
L_NOADVB:
    ds_read_b64_tr_b16 v[150:151], v229 offset:2048
    ds_read_b64_tr_b16 v[152:153], v229 offset:2560
    ds_read_b64_tr_b16 v[154:155], v229 offset:3072
    ds_read_b64_tr_b16 v[156:157], v229 offset:3584
    ds_write_b64 v220, v[10:11]
    ds_write_b16 v221, v10
    ds_write_b64 v164, v[172:173]
    ds_write_b16 v165, v222
    ds_write2_b32 v225, v223, v223 offset0:0 offset1:1
    ds_read_b128 v[158:161], v228 offset:0
    v_exp_f32 v70, v46
    v_exp_f32 v71, v47
    v_exp_f32 v72, v48
    v_exp_f32 v73, v49
    v_exp_f32 v74, v50
    v_exp_f32 v75, v51
    v_exp_f32 v76, v52
    v_exp_f32 v77, v53
    v_exp_f32 v78, v54
    v_exp_f32 v79, v55
    v_exp_f32 v80, v56
    v_exp_f32 v81, v57
    v_exp_f32 v82, v58
    v_exp_f32 v83, v59
    v_exp_f32 v84, v60
    v_exp_f32 v85, v61
    v_pk_add_f32 v[70:71], v[70:71], 1.0 op_sel_hi:[1,0]
    v_pk_add_f32 v[72:73], v[72:73], 1.0 op_sel_hi:[1,0]
    v_pk_add_f32 v[74:75], v[74:75], 1.0 op_sel_hi:[1,0]
    v_pk_add_f32 v[76:77], v[76:77], 1.0 op_sel_hi:[1,0]
    v_pk_add_f32 v[78:79], v[78:79], 1.0 op_sel_hi:[1,0]
    v_pk_add_f32 v[80:81], v[80:81], 1.0 op_sel_hi:[1,0]
    v_pk_add_f32 v[82:83], v[82:83], 1.0 op_sel_hi:[1,0]
    v_pk_add_f32 v[84:85], v[84:85], 1.0 op_sel_hi:[1,0]
    v_pk_mov_b32 v[220:221], v[164:165], v[164:165] op_sel:[0,1]
    s_waitcnt vmcnt(0) lgkmcnt(0)
    v_lshlrev_b32 v14, 16, v30
    v_lshlrev_b32 v15, 16, v31
    v_lshlrev_b32 v16, 16, v32
    v_lshlrev_b32 v17, 16, v33
    v_lshlrev_b32 v18, 16, v34
    v_lshlrev_b32 v19, 16, v35
    v_lshlrev_b32 v20, 16, v36
    v_lshlrev_b32 v21, 16, v37
    v_lshlrev_b32 v22, 16, v38
    v_lshlrev_b32 v23, 16, v39
    v_lshlrev_b32 v24, 16, v40
    v_lshlrev_b32 v25, 16, v41
    v_lshlrev_b32 v26, 16, v42
    v_lshlrev_b32 v27, 16, v43
    v_lshlrev_b32 v28, 16, v44
    v_lshlrev_b32 v29, 16, v45
    v_rcp_f32 v70, v70
    v_rcp_f32 v71, v71
    v_mfma_f32_32x32x16_bf16 v[14:29], v[158:161], v[2:5], v[14:29]
    v_rcp_f32 v72, v72
    v_rcp_f32 v73, v73
    v_rcp_f32 v74, v74
    v_rcp_f32 v75, v75
    v_mfma_f32_32x32x16_bf16 v[30:45], v[158:161], v[6:9], v[30:45]
    v_rcp_f32 v76, v76
    v_rcp_f32 v77, v77
    v_rcp_f32 v78, v78
    v_rcp_f32 v79, v79
    v_rcp_f32 v80, v80
    v_rcp_f32 v81, v81
    v_rcp_f32 v82, v82
    v_rcp_f32 v83, v83
    v_rcp_f32 v84, v84
    v_rcp_f32 v85, v85
    v_pk_mul_f32 v[70:71], v[70:71], v[46:47]
    v_pk_mul_f32 v[72:73], v[72:73], v[48:49]
    v_pk_mul_f32 v[74:75], v[74:75], v[50:51]
    v_pk_mul_f32 v[76:77], v[76:77], v[52:53]
    v_pk_mul_f32 v[78:79], v[78:79], v[54:55]
    v_pk_mul_f32 v[80:81], v[80:81], v[56:57]
    v_pk_mul_f32 v[82:83], v[82:83], v[58:59]
    v_pk_mul_f32 v[84:85], v[84:85], v[60:61]
    v_cvt_pk_bf16_f32 v94, v70, v71
    v_cvt_pk_bf16_f32 v95, v72, v73
    v_cvt_pk_bf16_f32 v96, v74, v75
    v_cvt_pk_bf16_f32 v97, v76, v77
    v_cvt_pk_bf16_f32 v98, v78, v79
    v_cvt_pk_bf16_f32 v99, v80, v81
    v_cvt_pk_bf16_f32 v100, v82, v83
    v_cvt_pk_bf16_f32 v101, v84, v85
    s_sub_u32 s96, s96, 1
    s_cbranch_scc0 L_LOOP
    s_branch L_DRAIN
L_COMB:
    s_cmp_eq_u32 s64, 0
    s_cbranch_scc1 L_MORE
    s_ff1_i32_b32 s3, s64
    s_bitset0_b32 s64, s3
    s_mul_i32 s80, s3, 6144
    s_add_u32 s80, s80, 114688
    s_cmp_eq_u32 s3, 8
    s_cselect_b32 s80, s66, s80
    s_cmp_lt_i32 s3, 0
    s_cselect_b32 s80, 0x30000, s80
    v_add_u32 v168, s80, v247
    v_add_u32 v169, s80, v248
    ds_read_b128 v[70:73], v168
    ds_read_b128 v[74:77], v168 offset:16
    ds_read_b32 v78, v169 offset:1792
    ds_read_b32 v79, v169 offset:1920
    s_waitcnt lgkmcnt(0)
    v_pk_add_f32 v[176:177], v[176:177], v[70:71]
    v_pk_add_f32 v[178:179], v[178:179], v[72:73]
    v_pk_add_f32 v[180:181], v[180:181], v[74:75]
    v_pk_add_f32 v[182:183], v[182:183], v[76:77]
    v_add_f32 v238, v238, v78
    v_add_f32 v238, v238, v79
    s_or_b32 s3, s64, s63
    s_cbranch_scc1 L_COMB
    s_branch L_FINAL
L_ABORT:
    s_mov_b64 exec, -1
    v_mov_b32 v223, -1
    ds_write_b32 v10, v223 offset:15344
    s_waitcnt lgkmcnt(0)
    s_endpgm
L_MORE:
    s_add_u32 s62, s62, 1
    s_cmp_ge_u32 s62, 256
    s_cbranch_scc1 L_FINAL
    v_add_u32 v244, s27, v244
    s_lshl_b32 s3, s27, 3
    s_add_u32 s14, s14, s3
    s_add_u32 s15, s15, s3
    s_add_u32 s16, s16, s3
    s_add_u32 s17, s17, s3
    s_setprio 0
    s_barrier
    s_mul_i32 s3, s61, 6144
    s_add_u32 s3, s3, 114688
    v_lshl_add_u32 v70, v1, 4, s3
    ds_write_b128 v70, v[10:13] offset:0
    ds_write_b128 v70, v[10:13] offset:1024
    ds_write_b128 v70, v[10:13] offset:2048
    ds_write_b128 v70, v[10:13] offset:3072
    ds_write_b128 v70, v[10:13] offset:4096
    ds_write_b128 v70, v[10:13] offset:5120
L_AGAIN:
    v_lshlrev_b32 v70, 1, v0
    v_and_b32 v70, 0x3fc, v70
    ds_write_b32 v70, v10 offset:15360
    ds_write_b32 v10, v10 offset:15352
    s_mov_b32 s96, 0
    s_mov_b32 s99, 1
    s_cmp_lg_u32 s61, 7
    s_cbranch_scc1 L_AGAIN2
    s_and_b32 s48, s2, 7
    s_lshl_b32 s48, s48, 12
    s_add_u32 s48, s48, 2424832
    v_lshlrev_b32 v224, 4, v1
    buffer_load_dwordx4 v[14:17], v224, s[36:39], s48 offen offset:0 sc1
    buffer_load_dwordx4 v[18:21], v224, s[36:39], s48 offen offset:1024 sc1
    buffer_load_dwordx4 v[22:25], v224, s[36:39], s48 offen offset:2048 sc1
    buffer_load_dwordx4 v[26:29], v224, s[36:39], s48 offen offset:3072 sc1
    s_waitcnt vmcnt(0)
L_AGAIN2:
    v_mov_b32 v164, s50
    v_mov_b32 v165, 0x3800
    v_mov_b32 v166, s51
    v_mov_b32 v167, 0x3800
    v_pk_mov_b32 v[102:103], v[164:165], v[164:165] op_sel:[0,1]
    v_pk_mov_b32 v[104:105], v[166:167], v[166:167] op_sel:[0,1]
    v_pk_mov_b32 v[106:107], v[164:165], v[164:165] op_sel:[0,1]
    v_pk_mov_b32 v[108:109], v[166:167], v[166:167] op_sel:[0,1]
    v_pk_mov_b32 v[110:111], v[164:165], v[164:165] op_sel:[0,1]
    v_pk_mov_b32 v[112:113], v[166:167], v[166:167] op_sel:[0,1]
    v_pk_mov_b32 v[114:115], v[164:165], v[164:165] op_sel:[0,1]
    v_pk_mov_b32 v[116:117], v[166:167], v[166:167] op_sel:[0,1]
    v_pk_mov_b32 v[118:119], v[164:165], v[164:165] op_sel:[0,1]
    v_pk_mov_b32 v[120:121], v[166:167], v[166:167] op_sel:[0,1]
    v_pk_mov_b32 v[122:123], v[164:165], v[164:165] op_sel:[0,1]
    v_pk_mov_b32 v[124:125], v[166:167], v[166:167] op_sel:[0,1]
    v_pk_mov_b32 v[126:127], v[164:165], v[164:165] op_sel:[0,1]
    v_pk_mov_b32 v[128:129], v[166:167], v[166:167] op_sel:[0,1]
    v_pk_mov_b32 v[130:131], v[164:165], v[164:165] op_sel:[0,1]
    v_pk_mov_b32 v[132:133], v[166:167], v[166:167] op_sel:[0,1]
    s_waitcnt lgkmcnt(0)
    s_barrier
    s_branch L_ROUND
.section .rodata,"a"
.p2align 6
.amdhsa_kernel gather_scatter__cheap_equivariant_egnn__graph_kernel
  .amdhsa_next_free_vgpr 254
  .amdhsa_next_free_sgpr 102
  .amdhsa_accum_offset 256
  .amdhsa_group_segment_fixed_size 0
  .amdhsa_kernarg_size 88
  .amdhsa_user_sgpr_count 2
  .amdhsa_user_sgpr_kernarg_segment_ptr 1
  .amdhsa_system_sgpr_workgroup_id_x 1
  .amdhsa_float_denorm_mode_32 3
.end_amdhsa_kernel
```
